```python
import torch

def _softmax(x, axis=-1):
    return torch.softmax(x, dim=axis)
def _gelu(x):
    return torch.nn.functional.gelu(x, approximate="tanh")
def _silu(x):
    return torch.nn.functional.silu(x)
def _sigmoid(x):
    return torch.sigmoid(x)
def _layernorm(x, axis=-1, eps=1e-5):
    m = x.mean(dim=axis, keepdim=True)
    v = x.var(dim=axis, keepdim=True, unbiased=False)
    return (x - m) / torch.sqrt(v + eps)
def _scatter_add(tgt, idx, src, axis=0):
    return tgt.clone().index_add_(axis, idx, src)
def _segment_sum(src, seg, n):
    out = torch.zeros((n,) + src.shape[1:], dtype=src.dtype)
    return out.index_add_(0, seg, src)
def _pad(x, pw):
    flat = tuple(v for pair in reversed(pw) for v in pair)
    return torch.nn.functional.pad(x, flat)

kernel_name = 'gated_mix__softmax_full_mha__linear_kernel_hedgehog__prompt'

def setup_inputs():

    _w = (lambda a: (lambda t: t.to(torch.bfloat16) if t.is_floating_point() else t)(torch.as_tensor(a)))
    def _A_setup():
        B, S, D = 1, 2048, 1024
        return {
            "x": _w((lambda *s: torch.randn(*s, dtype=torch.bfloat16) * 0.05)(B, S, D)),
            "wqkv": _w((lambda *s: torch.randn(*s, dtype=torch.bfloat16) * 3.2)(D, 3 * D)),
            "wo": _w((lambda *s: torch.randn(*s, dtype=torch.bfloat16) * 0.1)(D, D)),
        }
    _A_in = _A_setup()

    def _B_setup():
        B, S, D, H = 1, 2048, 1024, 32
        Dh = D // H
        return {
            "x": _w((lambda *s: torch.randn(*s, dtype=torch.bfloat16) * 0.05)(B, S, D)),
            "wqkv": _w((lambda *s: torch.randn(*s, dtype=torch.bfloat16) * 3.2)(D, 3 * D)),
            "w_phi": _w((lambda *s: torch.randn(*s, dtype=torch.bfloat16) * 3.2)(H, Dh, Dh) * (Dh ** -0.5)),
            "wo": _w((lambda *s: torch.randn(*s, dtype=torch.bfloat16) * 1.6)(D, D)),
        }
    _B_in = _B_setup()

    return {
        "A_x": _A_in["x"],
        "A_wqkv": _A_in["wqkv"],
        "A_wo": _A_in["wo"],
        "B_x": _B_in["x"],
        "B_wqkv": _B_in["wqkv"],
        "B_w_phi": _B_in["w_phi"],
        "B_wo": _B_in["wo"],
        "gate_w": _w((lambda *s: torch.randn(*s, dtype=torch.bfloat16) * 0.4)(1024) * 16.0),
    }

def reference(A_x, A_wqkv, A_wo, B_x, B_wqkv, B_w_phi, B_wo, gate_w):
    def _A_ref(x, wqkv, wo):
        B, S, D = x.shape
        H = 32; Dh = D // H
        qkv = (lambda x, *d: x.permute(*d))((x @ wqkv).reshape(B, S, 3, H, Dh), 2, 0, 3, 1, 4)
        q, k, v = qkv[0], qkv[1], qkv[2]
        scale = Dh ** -0.5
        scores = torch.einsum("bhqd,bhkd->bhqk", q, k) * scale
        p = _softmax(scores, axis=-1)
        o = torch.einsum("bhqk,bhkd->bhqd", p, v)
        return (lambda x, *d: x.permute(*d))(o, 0, 2, 1, 3).reshape(B, S, D) @ wo

    def _B_ref(x, wqkv, w_phi, wo):
        B, S, D = x.shape
        H = 32; Dh = D // H
        qkv = (lambda x, *d: x.permute(*d))((x @ wqkv).reshape(B, S, 3, H, Dh), 2, 0, 3, 1, 4)
        q, k, v = qkv[0], qkv[1], qkv[2]
        pq = torch.einsum("bhsd,hdf->bhsf", q, w_phi)
        pk = torch.einsum("bhsd,hdf->bhsf", k, w_phi)
        phi_q = torch.concatenate([_softmax(pq, axis=-1), _softmax(-pq, axis=-1)], axis=-1)
        phi_k = torch.concatenate([_softmax(pk, axis=-1), _softmax(-pk, axis=-1)], axis=-1)
        kv = torch.einsum("bhsf,bhsd->bhfd", phi_k, v)
        z  = torch.einsum("bhsf->bhf", phi_k)
        num = torch.einsum("bhqf,bhfd->bhqd", phi_q, kv)
        den = torch.einsum("bhqf,bhf->bhq", phi_q, z)[..., None] + 1e-6
        o = num / den
        return (lambda x, *d: x.permute(*d))(o, 0, 2, 1, 3).reshape(B, S, D) @ wo

    x = A_x
    g = _sigmoid((x * gate_w).sum(-1, keepdims=True))
    a = _A_ref(x, A_wqkv, A_wo)
    b = _B_ref(x, B_wqkv, B_w_phi, B_wo)
    return g * a + (1 - g) * b
```

```asm
; @launch grid=(256,1,1) block=(512,1,1) lds=163840
.amdgcn_target "amdgcn-amd-amdhsa--gfx950"
.text
.globl gated_mix__softmax_full_mha__linear_kernel_hedgehog__prompt_kernel
.p2align 8
.type gated_mix__softmax_full_mha__linear_kernel_hedgehog__prompt_kernel,@function
gated_mix__softmax_full_mha__linear_kernel_hedgehog__prompt_kernel:
    s_cmp_ge_u32 s2, 256
    s_cbranch_scc1 L_end
    s_nop 0
    s_load_dwordx2 s[4:5], s[0:1], 0
    s_load_dwordx2 s[6:7], s[0:1], 8
    s_load_dwordx2 s[40:41], s[0:1], 32
    s_load_dwordx2 s[42:43], s[0:1], 80
    s_load_dwordx2 s[54:55], s[0:1], 40
    s_load_dwordx2 s[56:57], s[0:1], 56
    s_load_dwordx2 s[80:81], s[0:1], 64
    s_load_dwordx2 s[82:83], s[0:1], 16
    s_load_dwordx2 s[84:85], s[0:1], 48
    s_load_dwordx2 s[86:87], s[0:1], 72
    v_and_b32 v1, 63, v0
    v_lshrrev_b32_e64 v20, 6, v0
    s_nop 0
    v_readfirstlane_b32 s28, v20
    s_and_b32 s45, s2, 7
    s_lshr_b32 s30, s2, 3
    s_and_b32 s29, s30, 1
    s_lshr_b32 s30, s30, 1
    s_lshl_b32 s45, s45, 1
    s_add_u32 s29, s29, s45
    s_lshr_b32 s31, s28, 2
    s_bfe_u32 s32, s28, 0x10001
    s_and_b32 s33, s28, 1
    s_lshl_b32 s59, s29, 4
    s_add_u32 s59, s59, s30
    s_lshl_b32 s59, s59, 7
    s_add_u32 s59, s59, 29360128
    v_and_b32 v20, 15, v1
    v_lshrrev_b32 v21, 4, v1
    v_bfe_u32 v22, v1, 1, 3
    v_xor_b32 v21, v21, v22
    v_lshlrev_b32 v21, 4, v21
    v_lshl_add_u32 v20, v20, 7, v21
    s_lshl_b32 s45, s33, 13
    v_add_u32 v10, s45, v20
    v_xor_b32 v11, 64, v10
    v_lshrrev_b32 v20, 4, v1
    v_lshlrev_b32_e64 v20, 10, v20
    v_bfe_u32 v21, v1, 2, 2
    v_lshl_add_u32 v20, v21, 7, v20
    v_bfe_u32 v21, v1, 1, 1
    s_lshl_b32 s45, s32, 2
    v_or_b32 v21, s45, v21
    v_bfe_u32 v22, v1, 3, 1
    v_lshlrev_b32 v22, 2, v22
    v_xor_b32 v21, v21, v22
    v_bfe_u32 v22, v1, 4, 1
    v_lshlrev_b32 v22, 1, v22
    v_xor_b32 v21, v21, v22
    v_lshl_add_u32 v20, v21, 4, v20
    v_and_b32_e64 v21, 1, v1
    v_lshl_add_u32 v20, v21, 3, v20
    s_mul_i32 s45, s31, 12288
    s_add_u32 s45, s45, 49152
    v_add_u32 v16, s45, v20
    v_xor_b32 v17, 32, v16
    s_cmp_ge_u32 s28, 4
    s_cbranch_scc1 L_B
    v_lshrrev_b32 v20, 3, v1
    s_movk_i32 s45, 6144
    v_mul_lo_u32 v20, v20, s45
    v_and_b32_e64 v21, 7, v1
    v_bfe_u32 v22, v1, 4, 1
    v_lshlrev_b32 v22, 2, v22
    v_xor_b32 v21, v21, v22
    v_lshl_add_u32 v20, v21, 4, v20
    s_lshl_b32 s45, s29, 7
    v_add_u32_e64 v20, s45, v20
    s_and_b32 s48, s28, 1
    s_mul_i32 s46, s28, 6144
    s_add_u32 s46, s46, 49152
    s_mov_b32 s49, 0
    s_cmp_eq_u32 s48, 1
    s_cselect_b32 s49, 100352, s49
    v_add_u32_e64 v2, s49, v20
    s_mov_b32 s49, 48128
    s_cmp_eq_u32 s48, 1
    s_nop 0
    s_cselect_b32 s49, 148480, s49
    v_add_u32 v3, s49, v20
    v_xor_b32 v3, 32, v3
    s_mov_b32 s49, 96256
    s_cmp_eq_u32 s48, 1
    s_nop 0
    s_cselect_b32 s49, 2048, s49
    v_add_u32_e64 v4, s49, v20
    s_mov_b32 s49, 144384
    s_cmp_eq_u32 s48, 1
    s_nop 0
    s_cselect_b32 s49, 50176, s49
    v_add_u32 v5, s49, v20
    v_xor_b32 v5, 32, v5
    s_mov_b32 s49, 2048
    s_cmp_eq_u32 s48, 1
    s_nop 0
    s_cselect_b32 s49, 102400, s49
    v_add_u32_e64 v6, s49, v20
    s_mov_b32 s49, 50176
    s_cmp_eq_u32 s48, 1
    s_nop 0
    s_cselect_b32 s49, 150528, s49
    v_add_u32 v7, s49, v20
    v_xor_b32 v7, 32, v7
    s_lshl_b32 s48, s28, 1
    s_add_u32 s48, s48, 0
    s_lshl_b32 s49, s48, 2
    v_lshrrev_b32 v20, 4, v1
    v_add_u32 v20, s49, v20
    v_and_b32 v20, 7, v20
    v_and_b32 v21, 7, v1
    v_xor_b32 v20, v20, v21
    v_lshlrev_b32 v20, 4, v20
    v_lshrrev_b32 v21, 3, v1
    s_lshl_b32 s48, s48, 3
    s_lshl_b32 s49, s30, 7
    s_add_u32 s48, s48, s49
    v_add_u32 v21, s48, v21
    v_lshl_add_u32 v20, v21, 11, v20
    v_subrev_u32 v8, 0, v20
    s_lshl_b32 s48, s28, 1
    s_add_u32 s48, s48, 1
    s_lshl_b32 s49, s48, 2
    v_lshrrev_b32 v20, 4, v1
    v_add_u32 v20, s49, v20
    v_and_b32 v20, 7, v20
    v_and_b32 v21, 7, v1
    v_xor_b32 v20, v20, v21
    v_lshlrev_b32 v20, 4, v20
    v_lshrrev_b32 v21, 3, v1
    s_lshl_b32 s48, s48, 3
    s_lshl_b32 s49, s30, 7
    s_add_u32 s48, s48, s49
    v_add_u32_e64 v21, s48, v21
    v_lshl_add_u32 v20, v21, 11, v20
    v_subrev_u32 v9, 1024, v20
    s_lshl_b32 s47, s28, 11
    s_mov_b32 s38, 0
    s_mov_b32 s39, 0
    s_waitcnt lgkmcnt(0)
    s_mov_b32 s8, s4
    s_mov_b32 s9, s5
    s_mov_b32 s10, 0x400000
    s_mov_b32 s11, 0x20000
    s_mov_b32 s12, s6
    s_mov_b32 s13, s7
    s_mov_b32 s14, 0x600000
    s_mov_b32 s15, 0x20000
    s_mov_b32 s16, s40
    s_mov_b32 s17, s41
    s_mov_b32 s18, 0x600000
    s_mov_b32 s19, 0x20000
    s_mov_b32 s20, s42
    s_mov_b32 s21, s43
    s_mov_b32 s22, 0x10000000
    s_mov_b32 s23, 0x20000
    s_mov_b32 s4, s42
    s_mov_b32 s5, s43
    s_mov_b32 s6, 0x40000
    s_mov_b32 s7, 0x20000
    s_mov_b32 s24, s42
    s_mov_b32 s25, s43
    s_mov_b32 s26, 0x40000
    s_mov_b32 s27, 0x20000
    s_cmp_lt_u32 s28, 2
    s_cselect_b32 s24, s12, s16
    s_cselect_b32 s25, s13, s17
    s_nop 0
    s_mov_b32 s26, 0x600000
    s_mov_b32 s27, 0x20000
    s_add_u32 m0, s47, 0
    s_nop 0
    buffer_load_dwordx4 v8, s[8:11], s39 offen offset:0 lds
    buffer_load_dwordx4 v9, s[8:11], s39 offen offset:1024 lds
    s_add_u32 s39, s39, 131072
    s_add_u32 m0, s46, 0
    s_nop 0
    buffer_load_dwordx4 v2, s[24:27], s38 offen offset:0 lds
    buffer_load_dwordx4 v3, s[24:27], s38 offen offset:1024 lds
    buffer_load_dwordx4 v4, s[24:27], s38 offen offset:2048 lds
    buffer_load_dwordx4 v5, s[24:27], s38 offen offset:3072 lds
    s_add_u32 m0, m0, 4096
    s_nop 0
    s_nop 0
    buffer_load_dwordx4 v6, s[24:27], s38 offen offset:0 lds
    buffer_load_dwordx4 v7, s[24:27], s38 offen offset:1024 lds
    s_add_u32 s38, s38, 196608
    s_add_u32 m0, s47, 8192
    s_nop 0
    s_nop 0
    buffer_load_dwordx4 v8, s[8:11], s39 offen offset:0 lds
    buffer_load_dwordx4 v9, s[8:11], s39 offen offset:1024 lds
    s_add_u32 s39, s39, 4294836352
    s_barrier
    s_nop 0
    s_add_u32 m0, s46, 24576
    s_nop 0
    s_nop 0
    buffer_load_dwordx4 v2, s[24:27], s38 offen offset:0 lds
    buffer_load_dwordx4 v3, s[24:27], s38 offen offset:1024 lds
    buffer_load_dwordx4 v4, s[24:27], s38 offen offset:2048 lds
    buffer_load_dwordx4 v5, s[24:27], s38 offen offset:3072 lds
    s_add_u32 m0, m0, 4096
    s_nop 0
    s_nop 0
    buffer_load_dwordx4 v6, s[24:27], s38 offen offset:0 lds
    buffer_load_dwordx4 v7, s[24:27], s38 offen offset:1024 lds
    s_add_u32 s38, s38, 196608
    s_add_u32 m0, s47, 16384
    s_nop 0
    s_nop 0
    buffer_load_dwordx4 v8, s[8:11], s39 offen offset:0 lds
    buffer_load_dwordx4 v9, s[8:11], s39 offen offset:1024 lds
    s_add_u32 s39, s39, 131072
    s_add_u32 m0, s46, 49152
    s_nop 0
    s_nop 0
    buffer_load_dwordx4 v2, s[24:27], s38 offen offset:0 lds
    buffer_load_dwordx4 v3, s[24:27], s38 offen offset:1024 lds
    buffer_load_dwordx4 v4, s[24:27], s38 offen offset:2048 lds
    buffer_load_dwordx4 v5, s[24:27], s38 offen offset:3072 lds
    s_add_u32 m0, m0, 4096
    s_nop 0
    s_nop 0
    buffer_load_dwordx4 v6, s[24:27], s38 offen offset:0 lds
    buffer_load_dwordx4 v7, s[24:27], s38 offen offset:1024 lds
    s_add_u32 s38, s38, 196608
    s_add_u32 m0, s47, 24576
    s_nop 0
    s_nop 0
    buffer_load_dwordx4 v8, s[8:11], s39 offen offset:0 lds
    buffer_load_dwordx4 v9, s[8:11], s39 offen offset:1024 lds
    s_add_u32 s39, s39, 4294836352
    s_add_u32 m0, s46, 73728
    s_nop 0
    s_nop 0
    buffer_load_dwordx4 v2, s[24:27], s38 offen offset:0 lds
    buffer_load_dwordx4 v3, s[24:27], s38 offen offset:1024 lds
    buffer_load_dwordx4 v4, s[24:27], s38 offen offset:2048 lds
    buffer_load_dwordx4 v5, s[24:27], s38 offen offset:3072 lds
    s_mov_b32 s3, 73728
    s_mov_b32 s34, 0
    s_nop 0
    s_mov_b32 s35, 24576
    s_mov_b32 s36, 32768
    s_mov_b32 s37, 16384
    v_mov_b32 v18, v16
    v_mov_b32 v14, v10
    v_mov_b32 v19, v17
    v_mov_b32 v15, v11
    v_mov_b64 v[32:33], 0
    v_mov_b64 v[34:35], 0
    v_mov_b64 v[36:37], 0
    v_mov_b64 v[38:39], 0
    v_mov_b64 v[40:41], 0
    v_mov_b64 v[42:43], 0
    v_mov_b64 v[44:45], 0
    v_mov_b64 v[46:47], 0
    v_mov_b64 v[48:49], 0
    v_mov_b64 v[50:51], 0
    v_mov_b64 v[52:53], 0
    v_mov_b64 v[54:55], 0
    v_mov_b64 v[56:57], 0
    v_mov_b64 v[58:59], 0
    v_mov_b64 v[60:61], 0
    v_mov_b64 v[62:63], 0
    v_mov_b64 v[64:65], 0
    v_mov_b64 v[66:67], 0
    v_mov_b64 v[68:69], 0
    v_mov_b64 v[70:71], 0
    v_mov_b64 v[72:73], 0
    v_mov_b64 v[74:75], 0
    v_mov_b64 v[76:77], 0
    v_mov_b64 v[78:79], 0
    v_mov_b64 v[80:81], 0
    v_mov_b64 v[82:83], 0
    v_mov_b64 v[84:85], 0
    v_mov_b64 v[86:87], 0
    v_mov_b64 v[88:89], 0
    v_mov_b64 v[90:91], 0
    v_mov_b64 v[92:93], 0
    v_mov_b64 v[94:95], 0
    v_mov_b64 v[96:97], 0
    v_mov_b64 v[98:99], 0
    v_mov_b64 v[100:101], 0
    v_mov_b64 v[102:103], 0
    v_mov_b64 v[104:105], 0
    v_mov_b64 v[106:107], 0
    v_mov_b64 v[108:109], 0
    v_mov_b64 v[110:111], 0
    v_mov_b64 v[112:113], 0
    v_mov_b64 v[114:115], 0
    v_mov_b64 v[116:117], 0
    v_mov_b64 v[118:119], 0
    v_mov_b64 v[120:121], 0
    v_mov_b64 v[122:123], 0
    v_mov_b64 v[124:125], 0
    v_mov_b64 v[126:127], 0
    v_lshrrev_b32 v20, 2, v1
    v_lshlrev_b32 v20, 7, v20
    v_and_b32_e64 v21, 3, v1
    v_lshl_add_u32 v232, v21, 2, v20
    v_and_b32 v20, 15, v1
    v_lshlrev_b32_e64 v21, 7, v20
    s_lshl_b32 s48, s29, 11
    s_add_u32 s48, s48, 29360196
    v_add_u32 v21, s48, v21
    v_lshlrev_b32_e64 v22, 11, v20
    s_lshl_b32 s48, s30, 7
    s_add_u32 s48, s48, 29360192
    v_add_u32 v22, s48, v22
    v_and_b32 v20, 16, v1
    v_cmp_eq_u32 vcc, 0, v20
    s_nop 1
    v_cndmask_b32 v233, v22, v21, vcc
    v_lshrrev_b32 v20, 5, v1
    s_lshl_b32 s48, s29, 1
    v_add_u32 v20, s48, v20
    v_and_b32 v22, 31, v1
    s_and_b32 s49, s30, 1
    s_lshl_b32 s49, s49, 5
    v_add_u32 v22, s49, v22
    v_lshlrev_b32_e64 v22, 4, v22
    v_lshl_add_u32 v234, v20, 17, v22
    v_lshl_add_u32 v235, v20, 12, v22
    v_bfe_u32 v20, v1, 4, 1
    v_add_u32 v20, s48, v20
    v_and_b32 v21, 15, v1
    v_lshlrev_b32_e64 v21, 8, v21
    v_lshl_add_u32 v236, v20, 12, v21
    v_lshlrev_b32 v237, 7, v20
    s_and_b32 s48, s2, 1
    s_lshl_b32 s48, s48, 3
    s_lshr_b32 s49, s2, 5
    s_add_u32 s48, s48, s49
    s_lshl_b32 s48, s48, 7
    v_lshrrev_b32 v20, 3, v1
    s_and_b32 s49, s28, 3
    s_lshl_b32 s49, s49, 4
    v_add_u32 v20, s49, v20
    v_lshlrev_b32 v20, 11, v20
    v_and_b32 v21, 7, v1
    v_bfe_u32 v22, v1, 4, 1
    v_lshlrev_b32 v22, 2, v22
    v_xor_b32 v21, v21, v22
    v_lshl_add_u32 v20, v21, 4, v20
    v_add_u32_e64 v238, s48, v20
    v_add_u32 v239, 15360, v238
    s_waitcnt vmcnt(20)
    s_barrier
    ds_read_b128 v[128:131], v14 offset:0
    ds_read_b128 v[132:135], v14 offset:2048
    ds_read_b128 v[136:139], v14 offset:4096
    ds_read_b128 v[140:143], v14 offset:6144
    ds_read_b64_tr_b16 v[160:161], v18 offset:0
    ds_read_b64_tr_b16 v[162:163], v18 offset:512
    ds_read_b64_tr_b16 v[164:165], v19 offset:0
    ds_read_b64_tr_b16 v[166:167], v19 offset:512
    ds_read_b64_tr_b16 v[168:169], v18 offset:4096
    ds_read_b64_tr_b16 v[170:171], v18 offset:4608
    v_lshrrev_b32 v20, 5, v1
    v_lshlrev_b32 v20, 3, v20
    v_bfe_u32 v21, v1, 2, 2
    v_add_u32 v20, v20, v21
    v_lshlrev_b32 v20, 6, v20
    v_bfe_u32 v21, v1, 4, 1
    v_lshl_add_u32 v20, v21, 5, v20
    v_and_b32_e64 v21, 3, v1
    v_lshl_add_u32 v20, v21, 3, v20
    s_lshl_b32 s48, s32, 11
    s_nop 0
    s_add_u32 s48, s48, 149504
    v_add_u32_e64 v20, s48, v20
    ds_read_b64_tr_b16 v[184:185], v20
    ds_read_b64_tr_b16 v[186:187], v20 offset:256
    ds_read_b64_tr_b16 v[188:189], v20 offset:1024
    ds_read_b64_tr_b16 v[190:191], v20 offset:1280
    s_waitcnt lgkmcnt(0)
    s_mov_b32 s44, 13
L_loop_A:
    v_mfma_f32_16x16x32_bf16 v[32:35], v[160:163], v[128:131], v[32:35]
    ds_read_b64_tr_b16 v[172:173], v19 offset:4096
    s_add_u32 m0, s3, s46
    s_nop 0
    v_mfma_f32_16x16x32_bf16 v[36:39], v[160:163], v[132:135], v[36:39]
    ds_read_b64_tr_b16 v[174:175], v19 offset:4608
    v_mfma_f32_16x16x32_bf16 v[40:43], v[160:163], v[136:139], v[40:43]
    s_add_u32 m0, m0, 4096
    v_mfma_f32_16x16x32_bf16 v[44:47], v[160:163], v[140:143], v[44:47]
    ds_read_b64_tr_b16 v[176:177], v18 offset:8192
    v_mfma_f32_16x16x32_bf16 v[48:51], v[164:167], v[128:131], v[48:51]
    buffer_load_dwordx4 v6, s[24:27], s38 offen offset:0 lds
    ds_read_b64_tr_b16 v[178:179], v18 offset:8704
    v_mfma_f32_16x16x32_bf16 v[52:55], v[164:167], v[132:135], v[52:55]
    buffer_load_dwordx4 v7, s[24:27], s38 offen offset:1024 lds
    v_mfma_f32_16x16x32_bf16 v[56:59], v[164:167], v[136:139], v[56:59]
    ds_read_b64_tr_b16 v[180:181], v19 offset:8192
    v_mfma_f32_16x16x32_bf16 v[60:63], v[164:167], v[140:143], v[60:63]
    s_add_u32 m0, s36, s47
    s_nop 0
    v_mfma_f32_16x16x32_bf16 v[64:67], v[168:171], v[128:131], v[64:67]
    ds_read_b64_tr_b16 v[182:183], v19 offset:8704
    buffer_load_dwordx4 v8, s[8:11], s39 offen offset:0 lds
    v_mfma_f32_16x16x32_bf16 v[68:71], v[168:171], v[132:135], v[68:71]
    buffer_load_dwordx4 v9, s[8:11], s39 offen offset:1024 lds
    v_mfma_f32_16x16x32_bf16 v[72:75], v[168:171], v[136:139], v[72:75]
    s_add_u32 s38, s38, 196608
    v_mfma_f32_16x16x32_bf16 v[76:79], v[168:171], v[140:143], v[76:79]
    s_add_u32 s39, s39, 131072
    s_waitcnt lgkmcnt(0)
    s_nop 0
    v_mfma_f32_16x16x32_bf16 v[80:83], v[172:175], v[128:131], v[80:83]
    v_add_u32_e64 v18, s35, v16
    v_mfma_f32_16x16x32_bf16 v[84:87], v[172:175], v[132:135], v[84:87]
    v_mfma_f32_16x16x32_bf16 v[88:91], v[172:175], v[136:139], v[88:91]
    v_add_u32_e64 v19, s35, v17
    v_mfma_f32_16x16x32_bf16 v[92:95], v[172:175], v[140:143], v[92:95]
    s_waitcnt vmcnt(16)
    s_barrier
    v_mfma_f32_16x16x32_bf16 v[96:99], v[128:131], v[176:179], v[96:99]
    ds_read_b128 v[144:147], v15 offset:0
    s_add_u32 m0, s34, s46
    s_nop 0
    ds_read_b64_tr_b16 v[160:161], v18 offset:0
    v_mfma_f32_16x16x32_bf16 v[100:103], v[132:135], v[176:179], v[100:103]
    buffer_load_dwordx4 v2, s[24:27], s38 offen offset:0 lds
    ds_read_b64_tr_b16 v[162:163], v18 offset:512
    v_mfma_f32_16x16x32_bf16 v[104:107], v[136:139], v[176:179], v[104:107]
    ds_read_b128 v[148:151], v15 offset:2048
    buffer_load_dwordx4 v3, s[24:27], s38 offen offset:1024 lds
    ds_read_b64_tr_b16 v[164:165], v19 offset:0
    v_mfma_f32_16x16x32_bf16 v[108:111], v[140:143], v[176:179], v[108:111]
    ds_read_b64_tr_b16 v[166:167], v19 offset:512
    buffer_load_dwordx4 v4, s[24:27], s38 offen offset:2048 lds
    v_mfma_f32_16x16x32_bf16 v[112:115], v[128:131], v[180:183], v[112:115]
    ds_read_b128 v[152:155], v15 offset:4096
    ds_read_b64_tr_b16 v[168:169], v18 offset:4096
    buffer_load_dwordx4 v5, s[24:27], s38 offen offset:3072 lds
    v_mfma_f32_16x16x32_bf16 v[116:119], v[132:135], v[180:183], v[116:119]
    ds_read_b64_tr_b16 v[170:171], v18 offset:4608
    ds_read_b128 v[156:159], v15 offset:6144
    v_mfma_f32_16x16x32_bf16 v[120:123], v[136:139], v[180:183], v[120:123]
    s_mov_b32 s3, s34
    s_mov_b32 s34, s35
    s_add_u32 s35, s35, 24576
    v_mfma_f32_16x16x32_bf16 v[124:127], v[140:143], v[180:183], v[124:127]
    s_cmp_eq_u32 s35, 98304
    s_cselect_b32 s35, 0, s35
    s_waitcnt lgkmcnt(0)
    v_mfma_f32_16x16x32_bf16 v[32:35], v[160:163], v[144:147], v[32:35]
    ds_read_b64_tr_b16 v[172:173], v19 offset:4096
    s_add_u32 m0, s3, s46
    s_nop 0
    v_mfma_f32_16x16x32_bf16 v[36:39], v[160:163], v[148:151], v[36:39]
    ds_read_b64_tr_b16 v[174:175], v19 offset:4608
    s_add_u32 m0, m0, 4096
    v_mfma_f32_16x16x32_bf16 v[40:43], v[160:163], v[152:155], v[40:43]
    ds_read_b64_tr_b16 v[176:177], v18 offset:8192
    v_mfma_f32_16x16x32_bf16 v[44:47], v[160:163], v[156:159], v[44:47]
    buffer_load_dwordx4 v6, s[24:27], s38 offen offset:0 lds
    ds_read_b64_tr_b16 v[178:179], v18 offset:8704
    v_mfma_f32_16x16x32_bf16 v[48:51], v[164:167], v[144:147], v[48:51]
    buffer_load_dwordx4 v7, s[24:27], s38 offen offset:1024 lds
    v_mfma_f32_16x16x32_bf16 v[52:55], v[164:167], v[148:151], v[52:55]
    ds_read_b64_tr_b16 v[180:181], v19 offset:8192
    s_add_u32 m0, s36, s47
    s_nop 0
    v_mfma_f32_16x16x32_bf16 v[56:59], v[164:167], v[152:155], v[56:59]
    ds_read_b64_tr_b16 v[182:183], v19 offset:8704
    s_add_u32 m0, m0, 8192
    v_mfma_f32_16x16x32_bf16 v[60:63], v[164:167], v[156:159], v[60:63]
    buffer_load_dwordx4 v8, s[8:11], s39 offen offset:0 lds
    v_mfma_f32_16x16x32_bf16 v[64:67], v[168:171], v[144:147], v[64:67]
    buffer_load_dwordx4 v9, s[8:11], s39 offen offset:1024 lds
    s_add_u32 s38, s38, 196608
    v_mfma_f32_16x16x32_bf16 v[68:71], v[168:171], v[148:151], v[68:71]
    s_add_u32 s39, s39, 4294836352
    v_mfma_f32_16x16x32_bf16 v[72:75], v[168:171], v[152:155], v[72:75]
    s_add_u32 s36, s36, 16384
    s_cmp_eq_u32 s36, 49152
    v_mfma_f32_16x16x32_bf16 v[76:79], v[168:171], v[156:159], v[76:79]
    s_cselect_b32 s36, 0, s36
    s_waitcnt lgkmcnt(0)
    v_mfma_f32_16x16x32_bf16 v[80:83], v[172:175], v[144:147], v[80:83]
    v_add_u32_e64 v18, s35, v16
    v_mfma_f32_16x16x32_bf16 v[84:87], v[172:175], v[148:151], v[84:87]
    v_add_u32_e64 v19, s35, v17
    v_mfma_f32_16x16x32_bf16 v[88:91], v[172:175], v[152:155], v[88:91]
    v_add_u32_e64 v14, s37, v10
    v_mfma_f32_16x16x32_bf16 v[92:95], v[172:175], v[156:159], v[92:95]
    v_add_u32_e64 v15, s37, v11
    s_waitcnt vmcnt(16)
    s_barrier
    v_mfma_f32_16x16x32_bf16 v[96:99], v[144:147], v[176:179], v[96:99]
    ds_read_b128 v[128:131], v14 offset:0
    s_add_u32 m0, s34, s46
    s_nop 0
    ds_read_b64_tr_b16 v[160:161], v18 offset:0
    v_mfma_f32_16x16x32_bf16 v[100:103], v[148:151], v[176:179], v[100:103]
    buffer_load_dwordx4 v2, s[24:27], s38 offen offset:0 lds
    ds_read_b64_tr_b16 v[162:163], v18 offset:512
    ds_read_b128 v[132:135], v14 offset:2048
    v_mfma_f32_16x16x32_bf16 v[104:107], v[152:155], v[176:179], v[104:107]
    buffer_load_dwordx4 v3, s[24:27], s38 offen offset:1024 lds
    ds_read_b64_tr_b16 v[164:165], v19 offset:0
    ds_read_b64_tr_b16 v[166:167], v19 offset:512
    v_mfma_f32_16x16x32_bf16 v[108:111], v[156:159], v[176:179], v[108:111]
    buffer_load_dwordx4 v4, s[24:27], s38 offen offset:2048 lds
    ds_read_b128 v[136:139], v14 offset:4096
    ds_read_b64_tr_b16 v[168:169], v18 offset:4096
    v_mfma_f32_16x16x32_bf16 v[112:115], v[144:147], v[180:183], v[112:115]
    buffer_load_dwordx4 v5, s[24:27], s38 offen offset:3072 lds
    ds_read_b64_tr_b16 v[170:171], v18 offset:4608
    ds_read_b128 v[140:143], v14 offset:6144
    v_mfma_f32_16x16x32_bf16 v[116:119], v[148:151], v[180:183], v[116:119]
    s_mov_b32 s3, s34
    s_mov_b32 s34, s35
    s_add_u32 s35, s35, 24576
    v_mfma_f32_16x16x32_bf16 v[120:123], v[152:155], v[180:183], v[120:123]
    s_cmp_eq_u32 s35, 98304
    s_cselect_b32 s35, 0, s35
    s_nop 0
    s_add_u32 s37, s37, 16384
    v_mfma_f32_16x16x32_bf16 v[124:127], v[156:159], v[180:183], v[124:127]
    s_cmp_eq_u32 s37, 49152
    s_cselect_b32 s37, 0, s37
    s_waitcnt lgkmcnt(0)
    s_sub_u32 s44, s44, 1
    s_cmp_lg_u32 s44, 0
    s_cbranch_scc1 L_loop_A
    s_nop 0
    v_mfma_f32_16x16x32_bf16 v[32:35], v[160:163], v[128:131], v[32:35]
    ds_read_b64_tr_b16 v[172:173], v19 offset:4096
    s_add_u32 m0, s3, s46
    s_nop 0
    v_mfma_f32_16x16x32_bf16 v[36:39], v[160:163], v[132:135], v[36:39]
    ds_read_b64_tr_b16 v[174:175], v19 offset:4608
    v_mfma_f32_16x16x32_bf16 v[40:43], v[160:163], v[136:139], v[40:43]
    s_add_u32 m0, m0, 4096
    v_mfma_f32_16x16x32_bf16 v[44:47], v[160:163], v[140:143], v[44:47]
    ds_read_b64_tr_b16 v[176:177], v18 offset:8192
    v_mfma_f32_16x16x32_bf16 v[48:51], v[164:167], v[128:131], v[48:51]
    buffer_load_dwordx4 v6, s[24:27], s38 offen offset:0 lds
    ds_read_b64_tr_b16 v[178:179], v18 offset:8704
    v_mfma_f32_16x16x32_bf16 v[52:55], v[164:167], v[132:135], v[52:55]
    buffer_load_dwordx4 v7, s[24:27], s38 offen offset:1024 lds
    v_mfma_f32_16x16x32_bf16 v[56:59], v[164:167], v[136:139], v[56:59]
    ds_read_b64_tr_b16 v[180:181], v19 offset:8192
    v_mfma_f32_16x16x32_bf16 v[60:63], v[164:167], v[140:143], v[60:63]
    s_add_u32 m0, s36, s47
    s_nop 0
    v_mfma_f32_16x16x32_bf16 v[64:67], v[168:171], v[128:131], v[64:67]
    ds_read_b64_tr_b16 v[182:183], v19 offset:8704
    buffer_load_dwordx4 v8, s[8:11], s39 offen offset:0 lds
    v_mfma_f32_16x16x32_bf16 v[68:71], v[168:171], v[132:135], v[68:71]
    buffer_load_dwordx4 v9, s[8:11], s39 offen offset:1024 lds
    v_mfma_f32_16x16x32_bf16 v[72:75], v[168:171], v[136:139], v[72:75]
    s_add_u32 s38, s38, 196608
    v_mfma_f32_16x16x32_bf16 v[76:79], v[168:171], v[140:143], v[76:79]
    s_add_u32 s39, s39, 131072
    s_waitcnt lgkmcnt(0)
    s_nop 0
    v_mfma_f32_16x16x32_bf16 v[80:83], v[172:175], v[128:131], v[80:83]
    v_add_u32_e64 v18, s35, v16
    v_mfma_f32_16x16x32_bf16 v[84:87], v[172:175], v[132:135], v[84:87]
    v_mfma_f32_16x16x32_bf16 v[88:91], v[172:175], v[136:139], v[88:91]
    v_add_u32_e64 v19, s35, v17
    v_mfma_f32_16x16x32_bf16 v[92:95], v[172:175], v[140:143], v[92:95]
    s_waitcnt vmcnt(16)
    s_barrier
    v_mfma_f32_16x16x32_bf16 v[96:99], v[128:131], v[176:179], v[96:99]
    ds_read_b128 v[144:147], v15 offset:0
    s_add_u32 m0, s34, s46
    s_nop 0
    ds_read_b64_tr_b16 v[160:161], v18 offset:0
    v_mfma_f32_16x16x32_bf16 v[100:103], v[132:135], v[176:179], v[100:103]
    buffer_load_dwordx4 v2, s[24:27], s38 offen offset:0 lds
    ds_read_b64_tr_b16 v[162:163], v18 offset:512
    v_mfma_f32_16x16x32_bf16 v[104:107], v[136:139], v[176:179], v[104:107]
    ds_read_b128 v[148:151], v15 offset:2048
    buffer_load_dwordx4 v3, s[24:27], s38 offen offset:1024 lds
    ds_read_b64_tr_b16 v[164:165], v19 offset:0
    v_mfma_f32_16x16x32_bf16 v[108:111], v[140:143], v[176:179], v[108:111]
    ds_read_b64_tr_b16 v[166:167], v19 offset:512
    buffer_load_dwordx4 v4, s[24:27], s38 offen offset:2048 lds
    v_mfma_f32_16x16x32_bf16 v[112:115], v[128:131], v[180:183], v[112:115]
    ds_read_b128 v[152:155], v15 offset:4096
    ds_read_b64_tr_b16 v[168:169], v18 offset:4096
    buffer_load_dwordx4 v5, s[24:27], s38 offen offset:3072 lds
    v_mfma_f32_16x16x32_bf16 v[116:119], v[132:135], v[180:183], v[116:119]
    ds_read_b64_tr_b16 v[170:171], v18 offset:4608
    ds_read_b128 v[156:159], v15 offset:6144
    v_mfma_f32_16x16x32_bf16 v[120:123], v[136:139], v[180:183], v[120:123]
    s_mov_b32 s3, s34
    s_mov_b32 s34, s35
    s_add_u32 s35, s35, 24576
    v_mfma_f32_16x16x32_bf16 v[124:127], v[140:143], v[180:183], v[124:127]
    s_cmp_eq_u32 s35, 98304
    s_cselect_b32 s35, 0, s35
    s_waitcnt lgkmcnt(0)
    v_mfma_f32_16x16x32_bf16 v[32:35], v[160:163], v[144:147], v[32:35]
    ds_read_b64_tr_b16 v[172:173], v19 offset:4096
    s_add_u32 m0, s3, s46
    s_nop 0
    v_mfma_f32_16x16x32_bf16 v[36:39], v[160:163], v[148:151], v[36:39]
    ds_read_b64_tr_b16 v[174:175], v19 offset:4608
    s_add_u32 m0, m0, 4096
    v_mfma_f32_16x16x32_bf16 v[40:43], v[160:163], v[152:155], v[40:43]
    ds_read_b64_tr_b16 v[176:177], v18 offset:8192
    v_mfma_f32_16x16x32_bf16 v[44:47], v[160:163], v[156:159], v[44:47]
    buffer_load_dwordx4 v6, s[24:27], s38 offen offset:0 lds
    ds_read_b64_tr_b16 v[178:179], v18 offset:8704
    v_mfma_f32_16x16x32_bf16 v[48:51], v[164:167], v[144:147], v[48:51]
    buffer_load_dwordx4 v7, s[24:27], s38 offen offset:1024 lds
    v_mfma_f32_16x16x32_bf16 v[52:55], v[164:167], v[148:151], v[52:55]
    ds_read_b64_tr_b16 v[180:181], v19 offset:8192
    s_add_u32 m0, s36, s47
    s_nop 0
    v_mfma_f32_16x16x32_bf16 v[56:59], v[164:167], v[152:155], v[56:59]
    ds_read_b64_tr_b16 v[182:183], v19 offset:8704
    s_add_u32 m0, m0, 8192
    v_mfma_f32_16x16x32_bf16 v[60:63], v[164:167], v[156:159], v[60:63]
    buffer_load_dwordx4 v8, s[8:11], s39 offen offset:0 lds
    v_mfma_f32_16x16x32_bf16 v[64:67], v[168:171], v[144:147], v[64:67]
    buffer_load_dwordx4 v9, s[8:11], s39 offen offset:1024 lds
    s_add_u32 s38, s38, 196608
    v_mfma_f32_16x16x32_bf16 v[68:71], v[168:171], v[148:151], v[68:71]
    s_add_u32 s39, s39, 4294836352
    v_mfma_f32_16x16x32_bf16 v[72:75], v[168:171], v[152:155], v[72:75]
    s_add_u32 s36, s36, 16384
    s_cmp_eq_u32 s36, 49152
    v_mfma_f32_16x16x32_bf16 v[76:79], v[168:171], v[156:159], v[76:79]
    s_cselect_b32 s36, 0, s36
    s_waitcnt lgkmcnt(0)
    v_mfma_f32_16x16x32_bf16 v[80:83], v[172:175], v[144:147], v[80:83]
    v_add_u32_e64 v18, s35, v16
    v_mfma_f32_16x16x32_bf16 v[84:87], v[172:175], v[148:151], v[84:87]
    v_add_u32_e64 v19, s35, v17
    v_mfma_f32_16x16x32_bf16 v[88:91], v[172:175], v[152:155], v[88:91]
    v_add_u32_e64 v14, s37, v10
    v_mfma_f32_16x16x32_bf16 v[92:95], v[172:175], v[156:159], v[92:95]
    v_add_u32_e64 v15, s37, v11
    s_waitcnt vmcnt(16)
    s_barrier
    v_mfma_f32_16x16x32_bf16 v[96:99], v[144:147], v[176:179], v[96:99]
    ds_read_b128 v[128:131], v14 offset:0
    s_add_u32 m0, s34, s46
    s_nop 0
    ds_read_b64_tr_b16 v[160:161], v18 offset:0
    v_mfma_f32_16x16x32_bf16 v[100:103], v[148:151], v[176:179], v[100:103]
    buffer_load_dwordx4 v2, s[24:27], s38 offen offset:0 lds
    ds_read_b64_tr_b16 v[162:163], v18 offset:512
    ds_read_b128 v[132:135], v14 offset:2048
    v_mfma_f32_16x16x32_bf16 v[104:107], v[152:155], v[176:179], v[104:107]
    buffer_load_dwordx4 v3, s[24:27], s38 offen offset:1024 lds
    ds_read_b64_tr_b16 v[164:165], v19 offset:0
    ds_read_b64_tr_b16 v[166:167], v19 offset:512
    v_mfma_f32_16x16x32_bf16 v[108:111], v[156:159], v[176:179], v[108:111]
    buffer_load_dwordx4 v4, s[24:27], s38 offen offset:2048 lds
    ds_read_b128 v[136:139], v14 offset:4096
    ds_read_b64_tr_b16 v[168:169], v18 offset:4096
    v_mfma_f32_16x16x32_bf16 v[112:115], v[144:147], v[180:183], v[112:115]
    buffer_load_dwordx4 v5, s[24:27], s38 offen offset:3072 lds
    ds_read_b64_tr_b16 v[170:171], v18 offset:4608
    ds_read_b128 v[140:143], v14 offset:6144
    v_mfma_f32_16x16x32_bf16 v[116:119], v[148:151], v[180:183], v[116:119]
    s_mov_b32 s3, s34
    s_mov_b32 s34, s35
    s_add_u32 s35, s35, 24576
    v_mfma_f32_16x16x32_bf16 v[120:123], v[152:155], v[180:183], v[120:123]
    s_cmp_eq_u32 s35, 98304
    s_cselect_b32 s35, 0, s35
    s_nop 0
    s_add_u32 s37, s37, 16384
    v_mfma_f32_16x16x32_bf16 v[124:127], v[156:159], v[180:183], v[124:127]
    s_cmp_eq_u32 s37, 49152
    s_cselect_b32 s37, 0, s37
    s_waitcnt lgkmcnt(0)
    v_mfma_f32_16x16x32_bf16 v[32:35], v[160:163], v[128:131], v[32:35]
    ds_read_b64_tr_b16 v[172:173], v19 offset:4096
    v_mfma_f32_16x16x32_bf16 v[36:39], v[160:163], v[132:135], v[36:39]
    s_add_u32 m0, s3, s46
    s_nop 0
    v_mfma_f32_16x16x32_bf16 v[40:43], v[160:163], v[136:139], v[40:43]
    ds_read_b64_tr_b16 v[174:175], v19 offset:4608
    v_mfma_f32_16x16x32_bf16 v[44:47], v[160:163], v[140:143], v[44:47]
    s_add_u32 m0, m0, 4096
    v_mfma_f32_16x16x32_bf16 v[48:51], v[164:167], v[128:131], v[48:51]
    ds_read_b64_tr_b16 v[176:177], v18 offset:8192
    v_mfma_f32_16x16x32_bf16 v[52:55], v[164:167], v[132:135], v[52:55]
    buffer_load_dwordx4 v6, s[24:27], s38 offen offset:0 lds
    v_mfma_f32_16x16x32_bf16 v[56:59], v[164:167], v[136:139], v[56:59]
    ds_read_b64_tr_b16 v[178:179], v18 offset:8704
    v_mfma_f32_16x16x32_bf16 v[60:63], v[164:167], v[140:143], v[60:63]
    buffer_load_dwordx4 v7, s[24:27], s38 offen offset:1024 lds
    v_mfma_f32_16x16x32_bf16 v[64:67], v[168:171], v[128:131], v[64:67]
    ds_read_b64_tr_b16 v[180:181], v19 offset:8192
    v_mfma_f32_16x16x32_bf16 v[68:71], v[168:171], v[132:135], v[68:71]
    s_add_u32 s38, s38, 196608
    v_mfma_f32_16x16x32_bf16 v[72:75], v[168:171], v[136:139], v[72:75]
    ds_read_b64_tr_b16 v[182:183], v19 offset:8704
    v_mfma_f32_16x16x32_bf16 v[76:79], v[168:171], v[140:143], v[76:79]
    s_add_u32 s39, s39, 131072
    s_waitcnt lgkmcnt(0)
    s_nop 0
    v_mfma_f32_16x16x32_bf16 v[80:83], v[172:175], v[128:131], v[80:83]
    v_add_u32_e64 v18, s35, v16
    v_mfma_f32_16x16x32_bf16 v[84:87], v[172:175], v[132:135], v[84:87]
    v_mfma_f32_16x16x32_bf16 v[88:91], v[172:175], v[136:139], v[88:91]
    v_add_u32_e64 v19, s35, v17
    v_mfma_f32_16x16x32_bf16 v[92:95], v[172:175], v[140:143], v[92:95]
    s_waitcnt vmcnt(14)
    s_barrier
    v_mfma_f32_16x16x32_bf16 v[96:99], v[128:131], v[176:179], v[96:99]
    ds_read_b128 v[144:147], v15 offset:0
    ds_read_b64_tr_b16 v[160:161], v18 offset:0
    v_mfma_f32_16x16x32_bf16 v[100:103], v[132:135], v[176:179], v[100:103]
    ds_read_b64_tr_b16 v[162:163], v18 offset:512
    ds_read_b128 v[148:151], v15 offset:2048
    v_mfma_f32_16x16x32_bf16 v[104:107], v[136:139], v[176:179], v[104:107]
    ds_read_b64_tr_b16 v[164:165], v19 offset:0
    ds_read_b64_tr_b16 v[166:167], v19 offset:512
    v_mfma_f32_16x16x32_bf16 v[108:111], v[140:143], v[176:179], v[108:111]
    ds_read_b128 v[152:155], v15 offset:4096
    ds_read_b64_tr_b16 v[168:169], v18 offset:4096
    v_mfma_f32_16x16x32_bf16 v[112:115], v[128:131], v[180:183], v[112:115]
    ds_read_b64_tr_b16 v[170:171], v18 offset:4608
    ds_read_b128 v[156:159], v15 offset:6144
    v_mfma_f32_16x16x32_bf16 v[116:119], v[132:135], v[180:183], v[116:119]
    s_mov_b32 s3, s34
    s_mov_b32 s34, s35
    v_mfma_f32_16x16x32_bf16 v[120:123], v[136:139], v[180:183], v[120:123]
    s_add_u32 s35, s35, 24576
    s_cmp_eq_u32 s35, 98304
    v_mfma_f32_16x16x32_bf16 v[124:127], v[140:143], v[180:183], v[124:127]
    s_cselect_b32 s35, 0, s35
    s_waitcnt lgkmcnt(0)
    v_mfma_f32_16x16x32_bf16 v[32:35], v[160:163], v[144:147], v[32:35]
    ds_read_b64_tr_b16 v[172:173], v19 offset:4096
    v_mfma_f32_16x16x32_bf16 v[36:39], v[160:163], v[148:151], v[36:39]
    s_add_u32 s38, s38, 196608
    v_mfma_f32_16x16x32_bf16 v[40:43], v[160:163], v[152:155], v[40:43]
    ds_read_b64_tr_b16 v[174:175], v19 offset:4608
    v_mfma_f32_16x16x32_bf16 v[44:47], v[160:163], v[156:159], v[44:47]
    s_add_u32 s39, s39, 4294836352
    v_mfma_f32_16x16x32_bf16 v[48:51], v[164:167], v[144:147], v[48:51]
    ds_read_b64_tr_b16 v[176:177], v18 offset:8192
    v_mfma_f32_16x16x32_bf16 v[52:55], v[164:167], v[148:151], v[52:55]
    s_add_u32 s36, s36, 16384
    v_mfma_f32_16x16x32_bf16 v[56:59], v[164:167], v[152:155], v[56:59]
    ds_read_b64_tr_b16 v[178:179], v18 offset:8704
    v_mfma_f32_16x16x32_bf16 v[60:63], v[164:167], v[156:159], v[60:63]
    s_cmp_eq_u32 s36, 49152
    v_mfma_f32_16x16x32_bf16 v[64:67], v[168:171], v[144:147], v[64:67]
    ds_read_b64_tr_b16 v[180:181], v19 offset:8192
    v_mfma_f32_16x16x32_bf16 v[68:71], v[168:171], v[148:151], v[68:71]
    s_cselect_b32 s36, 0, s36
    s_nop 0
    v_mfma_f32_16x16x32_bf16 v[72:75], v[168:171], v[152:155], v[72:75]
    ds_read_b64_tr_b16 v[182:183], v19 offset:8704
    v_mfma_f32_16x16x32_bf16 v[76:79], v[168:171], v[156:159], v[76:79]
    s_waitcnt lgkmcnt(0)
    s_nop 0
    v_mfma_f32_16x16x32_bf16 v[80:83], v[172:175], v[144:147], v[80:83]
    v_add_u32_e64 v18, s35, v16
    v_mfma_f32_16x16x32_bf16 v[84:87], v[172:175], v[148:151], v[84:87]
    v_add_u32_e64 v19, s35, v17
    v_mfma_f32_16x16x32_bf16 v[88:91], v[172:175], v[152:155], v[88:91]
    v_add_u32_e64 v14, s37, v10
    v_mfma_f32_16x16x32_bf16 v[92:95], v[172:175], v[156:159], v[92:95]
    v_add_u32_e64 v15, s37, v11
    s_waitcnt vmcnt(6)
    s_barrier
    v_mfma_f32_16x16x32_bf16 v[96:99], v[144:147], v[176:179], v[96:99]
    ds_read_b128 v[128:131], v14 offset:0
    ds_read_b64_tr_b16 v[160:161], v18 offset:0
    ds_read_b64_tr_b16 v[162:163], v18 offset:512
    v_mfma_f32_16x16x32_bf16 v[100:103], v[148:151], v[176:179], v[100:103]
    ds_read_b128 v[132:135], v14 offset:2048
    ds_read_b64_tr_b16 v[164:165], v19 offset:0
    v_mfma_f32_16x16x32_bf16 v[104:107], v[152:155], v[176:179], v[104:107]
    ds_read_b64_tr_b16 v[166:167], v19 offset:512
    ds_read_b128 v[136:139], v14 offset:4096
    v_mfma_f32_16x16x32_bf16 v[108:111], v[156:159], v[176:179], v[108:111]
    ds_read_b64_tr_b16 v[168:169], v18 offset:4096
    ds_read_b64_tr_b16 v[170:171], v18 offset:4608
    v_mfma_f32_16x16x32_bf16 v[112:115], v[144:147], v[180:183], v[112:115]
    ds_read_b128 v[140:143], v14 offset:6144
    s_mov_b32 s3, s34
    s_mov_b32 s34, s35
    v_mfma_f32_16x16x32_bf16 v[116:119], v[148:151], v[180:183], v[116:119]
    s_add_u32 s35, s35, 24576
    s_cmp_eq_u32 s35, 98304
    v_mfma_f32_16x16x32_bf16 v[120:123], v[152:155], v[180:183], v[120:123]
    s_cselect_b32 s35, 0, s35
    s_nop 0
    s_add_u32 s37, s37, 16384
    v_mfma_f32_16x16x32_bf16 v[124:127], v[156:159], v[180:183], v[124:127]
    s_cmp_eq_u32 s37, 49152
    s_cselect_b32 s37, 0, s37
    s_waitcnt lgkmcnt(0)
    v_mfma_f32_16x16x32_bf16 v[32:35], v[160:163], v[128:131], v[32:35]
    ds_read_b64_tr_b16 v[172:173], v19 offset:4096
    v_mfma_f32_16x16x32_bf16 v[36:39], v[160:163], v[132:135], v[36:39]
    s_add_u32 s38, s38, 196608
    v_mfma_f32_16x16x32_bf16 v[40:43], v[160:163], v[136:139], v[40:43]
    v_mfma_f32_16x16x32_bf16 v[44:47], v[160:163], v[140:143], v[44:47]
    ds_read_b64_tr_b16 v[174:175], v19 offset:4608
    v_mfma_f32_16x16x32_bf16 v[48:51], v[164:167], v[128:131], v[48:51]
    ds_read_b64_tr_b16 v[176:177], v18 offset:8192
    v_mfma_f32_16x16x32_bf16 v[52:55], v[164:167], v[132:135], v[52:55]
    v_mfma_f32_16x16x32_bf16 v[56:59], v[164:167], v[136:139], v[56:59]
    s_add_u32 s39, s39, 131072
    v_mfma_f32_16x16x32_bf16 v[60:63], v[164:167], v[140:143], v[60:63]
    ds_read_b64_tr_b16 v[178:179], v18 offset:8704
    v_mfma_f32_16x16x32_bf16 v[64:67], v[168:171], v[128:131], v[64:67]
    v_mfma_f32_16x16x32_bf16 v[68:71], v[168:171], v[132:135], v[68:71]
    ds_read_b64_tr_b16 v[180:181], v19 offset:8192
    v_mfma_f32_16x16x32_bf16 v[72:75], v[168:171], v[136:139], v[72:75]
    ds_read_b64_tr_b16 v[182:183], v19 offset:8704
    v_mfma_f32_16x16x32_bf16 v[76:79], v[168:171], v[140:143], v[76:79]
    s_waitcnt lgkmcnt(0)
    s_nop 0
    v_mfma_f32_16x16x32_bf16 v[80:83], v[172:175], v[128:131], v[80:83]
    v_add_u32_e64 v18, s35, v16
    v_mfma_f32_16x16x32_bf16 v[84:87], v[172:175], v[132:135], v[84:87]
    v_mfma_f32_16x16x32_bf16 v[88:91], v[172:175], v[136:139], v[88:91]
    v_add_u32_e64 v19, s35, v17
    v_mfma_f32_16x16x32_bf16 v[92:95], v[172:175], v[140:143], v[92:95]
    s_waitcnt vmcnt(0)
    s_barrier
    v_mfma_f32_16x16x32_bf16 v[96:99], v[128:131], v[176:179], v[96:99]
    ds_read_b128 v[144:147], v15 offset:0
    ds_read_b64_tr_b16 v[160:161], v18 offset:0
    v_mfma_f32_16x16x32_bf16 v[100:103], v[132:135], v[176:179], v[100:103]
    ds_read_b64_tr_b16 v[162:163], v18 offset:512
    ds_read_b128 v[148:151], v15 offset:2048
    v_mfma_f32_16x16x32_bf16 v[104:107], v[136:139], v[176:179], v[104:107]
    ds_read_b64_tr_b16 v[164:165], v19 offset:0
    ds_read_b64_tr_b16 v[166:167], v19 offset:512
    v_mfma_f32_16x16x32_bf16 v[108:111], v[140:143], v[176:179], v[108:111]
    ds_read_b128 v[152:155], v15 offset:4096
    ds_read_b64_tr_b16 v[168:169], v18 offset:4096
    v_mfma_f32_16x16x32_bf16 v[112:115], v[128:131], v[180:183], v[112:115]
    ds_read_b64_tr_b16 v[170:171], v18 offset:4608
    ds_read_b128 v[156:159], v15 offset:6144
    v_mfma_f32_16x16x32_bf16 v[116:119], v[132:135], v[180:183], v[116:119]
    s_mov_b32 s3, s34
    s_mov_b32 s34, s35
    v_mfma_f32_16x16x32_bf16 v[120:123], v[136:139], v[180:183], v[120:123]
    s_add_u32 s35, s35, 24576
    s_cmp_eq_u32 s35, 98304
    v_mfma_f32_16x16x32_bf16 v[124:127], v[140:143], v[180:183], v[124:127]
    s_cselect_b32 s35, 0, s35
    s_waitcnt lgkmcnt(0)
    v_mfma_f32_16x16x32_bf16 v[32:35], v[160:163], v[144:147], v[32:35]
    ds_read_b64_tr_b16 v[172:173], v19 offset:4096
    v_mfma_f32_16x16x32_bf16 v[36:39], v[160:163], v[148:151], v[36:39]
    s_add_u32 s38, s38, 196608
    v_mfma_f32_16x16x32_bf16 v[40:43], v[160:163], v[152:155], v[40:43]
    ds_read_b64_tr_b16 v[174:175], v19 offset:4608
    v_mfma_f32_16x16x32_bf16 v[44:47], v[160:163], v[156:159], v[44:47]
    s_add_u32 s39, s39, 4294836352
    v_mfma_f32_16x16x32_bf16 v[48:51], v[164:167], v[144:147], v[48:51]
    ds_read_b64_tr_b16 v[176:177], v18 offset:8192
    v_mfma_f32_16x16x32_bf16 v[52:55], v[164:167], v[148:151], v[52:55]
    s_add_u32 s36, s36, 16384
    v_mfma_f32_16x16x32_bf16 v[56:59], v[164:167], v[152:155], v[56:59]
    ds_read_b64_tr_b16 v[178:179], v18 offset:8704
    v_mfma_f32_16x16x32_bf16 v[60:63], v[164:167], v[156:159], v[60:63]
    s_cmp_eq_u32 s36, 49152
    v_mfma_f32_16x16x32_bf16 v[64:67], v[168:171], v[144:147], v[64:67]
    ds_read_b64_tr_b16 v[180:181], v19 offset:8192
    v_mfma_f32_16x16x32_bf16 v[68:71], v[168:171], v[148:151], v[68:71]
    s_cselect_b32 s36, 0, s36
    s_nop 0
    v_mfma_f32_16x16x32_bf16 v[72:75], v[168:171], v[152:155], v[72:75]
    ds_read_b64_tr_b16 v[182:183], v19 offset:8704
    v_mfma_f32_16x16x32_bf16 v[76:79], v[168:171], v[156:159], v[76:79]
    s_waitcnt lgkmcnt(0)
    s_nop 0
    v_mfma_f32_16x16x32_bf16 v[80:83], v[172:175], v[144:147], v[80:83]
    v_mfma_f32_16x16x32_bf16 v[84:87], v[172:175], v[148:151], v[84:87]
    v_mfma_f32_16x16x32_bf16 v[88:91], v[172:175], v[152:155], v[88:91]
    v_mfma_f32_16x16x32_bf16 v[92:95], v[172:175], v[156:159], v[92:95]
    v_mfma_f32_16x16x32_bf16 v[96:99], v[144:147], v[176:179], v[96:99]
    v_mfma_f32_16x16x32_bf16 v[100:103], v[148:151], v[176:179], v[100:103]
    v_mfma_f32_16x16x32_bf16 v[104:107], v[152:155], v[176:179], v[104:107]
    v_mfma_f32_16x16x32_bf16 v[108:111], v[156:159], v[176:179], v[108:111]
    v_mfma_f32_16x16x32_bf16 v[112:115], v[144:147], v[180:183], v[112:115]
    v_mfma_f32_16x16x32_bf16 v[116:119], v[148:151], v[180:183], v[116:119]
    v_mfma_f32_16x16x32_bf16 v[120:123], v[152:155], v[180:183], v[120:123]
    v_mfma_f32_16x16x32_bf16 v[124:127], v[156:159], v[180:183], v[124:127]
    s_barrier
    s_nop 0
    v_mov_b32 v20, 49152
    ds_read_b32 v25, v20
    v_lshlrev_b32 v24, 4, v1
    s_lshl_b32 s48, s28, 12
    s_add_u32 s48, s48, 53248
    v_add_u32_e64 v20, s48, v24
    ds_read_b128 v[192:195], v20 offset:0
    ds_read_b128 v[196:199], v20 offset:1024
    ds_read_b128 v[200:203], v20 offset:2048
    ds_read_b128 v[204:207], v20 offset:3072
    s_lshl_b32 s48, s29, 1
    s_add_u32 s48, s48, s32
    s_lshl_b32 s48, s48, 6
    s_lshl_b32 s49, s30, 2
    s_add_u32 s48, s48, s49
    s_lshl_b32 s49, s33, 1
    s_add_u32 s48, s48, s49
    s_lshl_b32 s50, s48, 12
    s_add_u32 s50, s50, 4194304
    s_add_u32 s51, s50, 4096
    v_lshlrev_b32 v24, 4, v1
    s_lshl_b32 s48, s33, 14
    s_lshl_b32 s49, s32, 13
    s_add_u32 s48, s48, s49
    v_add_u32_e64 v20, s48, v24
    v_cvt_pk_bf16_f32 v128, v64, v65
    v_cvt_pk_bf16_f32 v129, v66, v67
    v_cvt_pk_bf16_f32 v130, v68, v69
    v_cvt_pk_bf16_f32 v131, v70, v71
    v_cvt_pk_bf16_f32 v132, v80, v81
    v_cvt_pk_bf16_f32 v133, v82, v83
    v_cvt_pk_bf16_f32 v134, v84, v85
    v_cvt_pk_bf16_f32 v135, v86, v87
    v_cvt_pk_bf16_f32 v136, v72, v73
    v_cvt_pk_bf16_f32 v137, v74, v75
    v_cvt_pk_bf16_f32 v138, v76, v77
    v_cvt_pk_bf16_f32 v139, v78, v79
    v_cvt_pk_bf16_f32 v140, v88, v89
    v_cvt_pk_bf16_f32 v141, v90, v91
    v_cvt_pk_bf16_f32 v142, v92, v93
    v_cvt_pk_bf16_f32 v143, v94, v95
    v_permlane16_swap_b32 v128, v130
    v_permlane16_swap_b32 v129, v131
    v_permlane16_swap_b32 v132, v134
    v_permlane16_swap_b32 v133, v135
    v_permlane16_swap_b32 v136, v138
    v_permlane16_swap_b32 v137, v139
    v_permlane16_swap_b32 v140, v142
    v_permlane16_swap_b32 v141, v143
    buffer_store_dwordx4 v[128:131], v24, s[20:23], s50 offen offset:0 sc1
    ds_write_b128 v20, v[128:131] offset:0
    buffer_store_dwordx4 v[132:135], v24, s[20:23], s50 offen offset:1024 sc1
    ds_write_b128 v20, v[132:135] offset:1024
    buffer_store_dwordx4 v[136:139], v24, s[20:23], s51 offen offset:0 sc1
    ds_write_b128 v20, v[136:139] offset:4096
    buffer_store_dwordx4 v[140:143], v24, s[20:23], s51 offen offset:1024 sc1
    ds_write_b128 v20, v[140:143] offset:5120
    v_cvt_pk_bf16_f32 v144, v96, v97
    v_cvt_pk_bf16_f32 v145, v98, v99
    v_cvt_pk_bf16_f32 v146, v112, v113
    v_cvt_pk_bf16_f32 v147, v114, v115
    v_cvt_pk_bf16_f32 v148, v100, v101
    v_cvt_pk_bf16_f32 v149, v102, v103
    v_cvt_pk_bf16_f32 v150, v116, v117
    v_cvt_pk_bf16_f32 v151, v118, v119
    v_cvt_pk_bf16_f32 v152, v104, v105
    v_cvt_pk_bf16_f32 v153, v106, v107
    v_cvt_pk_bf16_f32 v154, v120, v121
    v_cvt_pk_bf16_f32 v155, v122, v123
    v_cvt_pk_bf16_f32 v156, v108, v109
    v_cvt_pk_bf16_f32 v157, v110, v111
    v_cvt_pk_bf16_f32 v158, v124, v125
    v_cvt_pk_bf16_f32 v159, v126, v127
    v_permlane16_swap_b32 v144, v146
    v_permlane16_swap_b32 v145, v147
    v_permlane16_swap_b32 v148, v150
    v_permlane16_swap_b32 v149, v151
    v_permlane16_swap_b32 v152, v154
    v_permlane16_swap_b32 v153, v155
    v_permlane16_swap_b32 v156, v158
    v_permlane16_swap_b32 v157, v159
    v_permlane32_swap_b32 v144, v146
    v_permlane32_swap_b32 v145, v147
    v_permlane32_swap_b32 v148, v150
    v_permlane32_swap_b32 v149, v151
    v_permlane32_swap_b32 v152, v154
    v_permlane32_swap_b32 v153, v155
    v_permlane32_swap_b32 v156, v158
    v_permlane32_swap_b32 v157, v159
    buffer_store_dwordx4 v[144:147], v24, s[20:23], s50 offen offset:2048 sc1
    ds_write_b128 v20, v[144:147] offset:2048
    buffer_store_dwordx4 v[148:151], v24, s[20:23], s50 offen offset:3072 sc1
    ds_write_b128 v20, v[148:151] offset:3072
    buffer_store_dwordx4 v[152:155], v24, s[20:23], s51 offen offset:2048 sc1
    ds_write_b128 v20, v[152:155] offset:6144
    buffer_store_dwordx4 v[156:159], v24, s[20:23], s51 offen offset:3072 sc1
    ds_write_b128 v20, v[156:159] offset:7168
    s_mov_b32 s52, 0x3e8293ee
    s_mov_b32 s53, 0x3e8293ee
    v_pk_mul_f32 v[32:33], v[32:33], s[52:53]
    v_pk_mul_f32 v[34:35], v[34:35], s[52:53]
    v_pk_mul_f32 v[36:37], v[36:37], s[52:53]
    v_pk_mul_f32 v[38:39], v[38:39], s[52:53]
    v_pk_mul_f32 v[40:41], v[40:41], s[52:53]
    v_pk_mul_f32 v[42:43], v[42:43], s[52:53]
    v_pk_mul_f32 v[44:45], v[44:45], s[52:53]
    v_pk_mul_f32 v[46:47], v[46:47], s[52:53]
    v_pk_mul_f32 v[48:49], v[48:49], s[52:53]
    v_pk_mul_f32 v[50:51], v[50:51], s[52:53]
    v_pk_mul_f32 v[52:53], v[52:53], s[52:53]
    v_pk_mul_f32 v[54:55], v[54:55], s[52:53]
    v_pk_mul_f32 v[56:57], v[56:57], s[52:53]
    v_pk_mul_f32 v[58:59], v[58:59], s[52:53]
    v_pk_mul_f32 v[60:61], v[60:61], s[52:53]
    v_pk_mul_f32 v[62:63], v[62:63], s[52:53]
    v_cvt_pk_bf16_f32 v4, v32, v33
    v_cvt_pk_bf16_f32 v5, v34, v35
    v_cvt_pk_bf16_f32 v6, v36, v37
    v_cvt_pk_bf16_f32 v7, v38, v39
    v_cvt_pk_bf16_f32 v8, v48, v49
    v_cvt_pk_bf16_f32 v9, v50, v51
    v_cvt_pk_bf16_f32 v10, v52, v53
    v_cvt_pk_bf16_f32 v11, v54, v55
    v_cvt_pk_bf16_f32 v12, v40, v41
    v_cvt_pk_bf16_f32 v13, v42, v43
    v_cvt_pk_bf16_f32 v14, v44, v45
    v_cvt_pk_bf16_f32 v15, v46, v47
    v_cvt_pk_bf16_f32 v16, v56, v57
    v_cvt_pk_bf16_f32 v17, v58, v59
    v_cvt_pk_bf16_f32 v18, v60, v61
    v_cvt_pk_bf16_f32 v19, v62, v63
    v_permlane16_swap_b32 v4, v6
    v_permlane16_swap_b32 v5, v7
    v_permlane16_swap_b32 v8, v10
    v_permlane16_swap_b32 v9, v11
    v_permlane16_swap_b32 v12, v14
    v_permlane16_swap_b32 v13, v15
    v_permlane16_swap_b32 v16, v18
    v_permlane16_swap_b32 v17, v19
    s_lshl_b32 s48, s28, 12
    s_nop 0
    s_add_u32 s48, s48, 114688
    v_add_u32_e64 v20, s48, v24
    ds_write_b128 v20, v[4:7]
    ds_write_b128 v20, v[8:11] offset:1024
    ds_write_b128 v20, v[12:15] offset:2048
    ds_write_b128 v20, v[16:19] offset:3072
    s_waitcnt lgkmcnt(0)
    v_readfirstlane_b32 s58, v25
    v_mfma_f32_32x32x16_bf16 v[32:47], v[184:187], v[200:203], 0
    v_mfma_f32_32x32x16_bf16 v[32:47], v[188:191], v[204:207], v[32:47]
    s_nop 11
    s_nop 0
    v_max3_f32 v80, v32, v33, v34
    v_min3_f32 v82, v32, v33, v34
    v_max3_f32 v80, v80, v35, v36
    v_min3_f32 v82, v82, v35, v36
    v_max3_f32 v80, v80, v37, v38
    v_min3_f32 v82, v82, v37, v38
    v_max3_f32 v80, v80, v39, v40
    v_min3_f32 v82, v82, v39, v40
    v_max3_f32 v80, v80, v41, v42
    v_min3_f32 v82, v82, v41, v42
    v_max3_f32 v80, v80, v43, v44
    v_min3_f32 v82, v82, v43, v44
    v_max3_f32 v80, v80, v45, v46
    v_min3_f32 v82, v82, v45, v46
    v_max_f32 v80, v80, v47
    v_min_f32 v82, v82, v47
    v_mov_b32 v81, v80
    v_mov_b32 v83, v82
    s_nop 0
    v_permlane32_swap_b32 v80, v81
    v_permlane32_swap_b32 v82, v83
    v_max_f32 v80, v80, v81
    v_min_f32 v82, v82, v83
    v_mov_b32 v81, v80
    v_mov_b32_e64 v83, v82
    v_pk_add_f32 v[48:49], v[32:33], v[80:81] neg_lo:[0,1] neg_hi:[0,1]
    v_pk_add_f32 v[50:51], v[34:35], v[80:81] neg_lo:[0,1] neg_hi:[0,1]
    v_pk_add_f32 v[52:53], v[36:37], v[80:81] neg_lo:[0,1] neg_hi:[0,1]
    v_pk_add_f32 v[54:55], v[38:39], v[80:81] neg_lo:[0,1] neg_hi:[0,1]
    v_pk_add_f32 v[56:57], v[40:41], v[80:81] neg_lo:[0,1] neg_hi:[0,1]
    v_pk_add_f32 v[58:59], v[42:43], v[80:81] neg_lo:[0,1] neg_hi:[0,1]
    v_pk_add_f32 v[60:61], v[44:45], v[80:81] neg_lo:[0,1] neg_hi:[0,1]
    v_pk_add_f32 v[62:63], v[46:47], v[80:81] neg_lo:[0,1] neg_hi:[0,1]
    v_pk_add_f32 v[32:33], v[82:83], v[32:33] neg_lo:[0,1] neg_hi:[0,1]
    v_pk_add_f32 v[34:35], v[82:83], v[34:35] neg_lo:[0,1] neg_hi:[0,1]
    v_pk_add_f32 v[36:37], v[82:83], v[36:37] neg_lo:[0,1] neg_hi:[0,1]
    v_pk_add_f32 v[38:39], v[82:83], v[38:39] neg_lo:[0,1] neg_hi:[0,1]
    v_pk_add_f32 v[40:41], v[82:83], v[40:41] neg_lo:[0,1] neg_hi:[0,1]
    v_pk_add_f32 v[42:43], v[82:83], v[42:43] neg_lo:[0,1] neg_hi:[0,1]
    v_pk_add_f32 v[44:45], v[82:83], v[44:45] neg_lo:[0,1] neg_hi:[0,1]
    v_pk_add_f32 v[46:47], v[82:83], v[46:47] neg_lo:[0,1] neg_hi:[0,1]
    v_exp_f32 v48, v48
    v_exp_f32 v49, v49
    v_exp_f32 v50, v50
    v_exp_f32 v51, v51
    v_exp_f32 v52, v52
    v_exp_f32 v53, v53
    v_exp_f32 v54, v54
    v_exp_f32 v55, v55
    v_exp_f32 v56, v56
    v_exp_f32 v57, v57
    v_exp_f32 v58, v58
    v_exp_f32 v59, v59
    v_exp_f32 v60, v60
    v_exp_f32 v61, v61
    v_exp_f32 v62, v62
    v_exp_f32 v63, v63
    v_exp_f32 v32, v32
    v_exp_f32 v33, v33
    v_exp_f32 v34, v34
    v_exp_f32 v35, v35
    v_exp_f32 v36, v36
    v_exp_f32 v37, v37
    v_exp_f32 v38, v38
    v_exp_f32 v39, v39
    v_exp_f32 v40, v40
    v_exp_f32 v41, v41
    v_exp_f32 v42, v42
    v_exp_f32 v43, v43
    v_exp_f32 v44, v44
    v_exp_f32 v45, v45
    v_exp_f32 v46, v46
    v_exp_f32 v47, v47
    v_pk_add_f32 v[84:85], v[48:49], v[50:51]
    v_pk_add_f32 v[88:89], v[52:53], v[54:55]
    v_pk_add_f32 v[84:85], v[84:85], v[56:57]
    v_pk_add_f32 v[88:89], v[88:89], v[58:59]
    v_pk_add_f32 v[84:85], v[84:85], v[60:61]
    v_pk_add_f32 v[88:89], v[88:89], v[62:63]
    v_pk_add_f32 v[84:85], v[84:85], v[88:89]
    v_add_f32 v84, v84, v85
    v_mov_b32 v85, v84
    v_pk_add_f32 v[86:87], v[32:33], v[34:35]
    v_pk_add_f32 v[90:91], v[36:37], v[38:39]
    v_pk_add_f32 v[86:87], v[86:87], v[40:41]
    v_pk_add_f32 v[90:91], v[90:91], v[42:43]
    v_pk_add_f32 v[86:87], v[86:87], v[44:45]
    v_pk_add_f32 v[90:91], v[90:91], v[46:47]
    v_pk_add_f32 v[86:87], v[86:87], v[90:91]
    v_add_f32 v86, v86, v87
    v_mov_b32 v87, v86
    v_permlane32_swap_b32 v84, v85
    s_nop 0
    v_permlane32_swap_b32 v86, v87
    v_add_f32 v84, v84, v85
    v_add_f32 v86, v86, v87
    v_rcp_f32 v84, v84
    v_rcp_f32 v86, v86
    v_mov_b32 v85, v84
    v_mov_b32_e64 v87, v86
    v_pk_mul_f32 v[48:49], v[48:49], v[84:85]
    v_pk_mul_f32 v[32:33], v[32:33], v[86:87]
    v_pk_mul_f32 v[50:51], v[50:51], v[84:85]
    v_pk_mul_f32 v[34:35], v[34:35], v[86:87]
    v_pk_mul_f32 v[52:53], v[52:53], v[84:85]
    v_pk_mul_f32 v[36:37], v[36:37], v[86:87]
    v_pk_mul_f32 v[54:55], v[54:55], v[84:85]
    v_pk_mul_f32 v[38:39], v[38:39], v[86:87]
    v_pk_mul_f32 v[56:57], v[56:57], v[84:85]
    v_pk_mul_f32 v[40:41], v[40:41], v[86:87]
    v_pk_mul_f32 v[58:59], v[58:59], v[84:85]
    v_pk_mul_f32 v[42:43], v[42:43], v[86:87]
    v_pk_mul_f32 v[60:61], v[60:61], v[84:85]
    v_pk_mul_f32 v[44:45], v[44:45], v[86:87]
    v_pk_mul_f32 v[62:63], v[62:63], v[84:85]
    v_pk_mul_f32 v[46:47], v[46:47], v[86:87]
    v_cvt_pk_bf16_f32 v64, v48, v49
    v_cvt_pk_bf16_f32 v65, v50, v51
    v_cvt_pk_bf16_f32 v66, v52, v53
    v_cvt_pk_bf16_f32 v67, v54, v55
    v_cvt_pk_bf16_f32 v68, v56, v57
    v_cvt_pk_bf16_f32 v69, v58, v59
    v_cvt_pk_bf16_f32 v70, v60, v61
    v_cvt_pk_bf16_f32 v71, v62, v63
    v_cvt_pk_bf16_f32 v72, v32, v33
    v_cvt_pk_bf16_f32 v73, v34, v35
    v_cvt_pk_bf16_f32 v74, v36, v37
    v_cvt_pk_bf16_f32 v75, v38, v39
    v_cvt_pk_bf16_f32 v76, v40, v41
    v_cvt_pk_bf16_f32 v77, v42, v43
    v_cvt_pk_bf16_f32 v78, v44, v45
    v_cvt_pk_bf16_f32 v79, v46, v47
    s_lshl_b32 s48, s28, 12
    s_nop 0
    s_add_u32 s48, s48, 131072
    v_add_u32_e64 v22, s48, v24
    ds_write_b128 v22, v[64:67] offset:0
    ds_write_b128 v22, v[68:71] offset:1024
    ds_write_b128 v22, v[72:75] offset:2048
    ds_write_b128 v22, v[76:79] offset:3072
    s_lshl_b32 s48, s28, 2
    s_add_u32 s48, s48, s59
    s_waitcnt vmcnt(0)
    v_mov_b32 v20, 0
    v_mov_b32_e64 v21, s58
    v_cmp_eq_u32 vcc, 0, v1
    s_and_saveexec_b64 s[50:51], vcc
    buffer_store_dword v21, v20, s[20:23], s48 offen sc1
    s_mov_b64 exec, s[50:51]
    s_nop 0
    v_mfma_f32_32x32x16_bf16 v[32:47], v[184:187], v[192:195], 0
    v_mfma_f32_32x32x16_bf16 v[32:47], v[188:191], v[196:199], v[32:47]
    s_nop 11
    s_nop 0
    v_max3_f32 v80, v32, v33, v34
    v_min3_f32 v82, v32, v33, v34
    v_max3_f32 v80, v80, v35, v36
    v_min3_f32 v82, v82, v35, v36
    v_max3_f32 v80, v80, v37, v38
    v_min3_f32 v82, v82, v37, v38
    v_max3_f32 v80, v80, v39, v40
    v_min3_f32 v82, v82, v39, v40
    v_max3_f32 v80, v80, v41, v42
    v_min3_f32 v82, v82, v41, v42
    v_max3_f32 v80, v80, v43, v44
    v_min3_f32 v82, v82, v43, v44
    v_max3_f32 v80, v80, v45, v46
    v_min3_f32 v82, v82, v45, v46
    v_max_f32 v80, v80, v47
    v_min_f32 v82, v82, v47
    v_mov_b32 v81, v80
    v_mov_b32 v83, v82
    s_nop 0
    v_permlane32_swap_b32 v80, v81
    v_permlane32_swap_b32 v82, v83
    v_max_f32 v80, v80, v81
    v_min_f32 v82, v82, v83
    v_mov_b32 v81, v80
    v_mov_b32_e64 v83, v82
    v_pk_add_f32 v[48:49], v[32:33], v[80:81] neg_lo:[0,1] neg_hi:[0,1]
    v_pk_add_f32 v[50:51], v[34:35], v[80:81] neg_lo:[0,1] neg_hi:[0,1]
    v_pk_add_f32 v[52:53], v[36:37], v[80:81] neg_lo:[0,1] neg_hi:[0,1]
    v_pk_add_f32 v[54:55], v[38:39], v[80:81] neg_lo:[0,1] neg_hi:[0,1]
    v_pk_add_f32 v[56:57], v[40:41], v[80:81] neg_lo:[0,1] neg_hi:[0,1]
    v_pk_add_f32 v[58:59], v[42:43], v[80:81] neg_lo:[0,1] neg_hi:[0,1]
    v_pk_add_f32 v[60:61], v[44:45], v[80:81] neg_lo:[0,1] neg_hi:[0,1]
    v_pk_add_f32 v[62:63], v[46:47], v[80:81] neg_lo:[0,1] neg_hi:[0,1]
    v_pk_add_f32 v[32:33], v[82:83], v[32:33] neg_lo:[0,1] neg_hi:[0,1]
    v_pk_add_f32 v[34:35], v[82:83], v[34:35] neg_lo:[0,1] neg_hi:[0,1]
    v_pk_add_f32 v[36:37], v[82:83], v[36:37] neg_lo:[0,1] neg_hi:[0,1]
    v_pk_add_f32 v[38:39], v[82:83], v[38:39] neg_lo:[0,1] neg_hi:[0,1]
    v_pk_add_f32 v[40:41], v[82:83], v[40:41] neg_lo:[0,1] neg_hi:[0,1]
    v_pk_add_f32 v[42:43], v[82:83], v[42:43] neg_lo:[0,1] neg_hi:[0,1]
    v_pk_add_f32 v[44:45], v[82:83], v[44:45] neg_lo:[0,1] neg_hi:[0,1]
    v_pk_add_f32 v[46:47], v[82:83], v[46:47] neg_lo:[0,1] neg_hi:[0,1]
    v_exp_f32 v48, v48
    v_exp_f32 v49, v49
    v_exp_f32 v50, v50
    v_exp_f32 v51, v51
    v_exp_f32 v52, v52
    v_exp_f32 v53, v53
    v_exp_f32 v54, v54
    v_exp_f32 v55, v55
    v_exp_f32 v56, v56
    v_exp_f32 v57, v57
    v_exp_f32 v58, v58
    v_exp_f32 v59, v59
    v_exp_f32 v60, v60
    v_exp_f32 v61, v61
    v_exp_f32 v62, v62
    v_exp_f32 v63, v63
    v_exp_f32 v32, v32
    v_exp_f32 v33, v33
    v_exp_f32 v34, v34
    v_exp_f32 v35, v35
    v_exp_f32 v36, v36
    v_exp_f32 v37, v37
    v_exp_f32 v38, v38
    v_exp_f32 v39, v39
    v_exp_f32 v40, v40
    v_exp_f32 v41, v41
    v_exp_f32 v42, v42
    v_exp_f32 v43, v43
    v_exp_f32 v44, v44
    v_exp_f32 v45, v45
    v_exp_f32 v46, v46
    v_exp_f32 v47, v47
    v_pk_add_f32 v[84:85], v[48:49], v[50:51]
    v_pk_add_f32 v[88:89], v[52:53], v[54:55]
    v_pk_add_f32 v[84:85], v[84:85], v[56:57]
    v_pk_add_f32 v[88:89], v[88:89], v[58:59]
    v_pk_add_f32 v[84:85], v[84:85], v[60:61]
    v_pk_add_f32 v[88:89], v[88:89], v[62:63]
    v_pk_add_f32 v[84:85], v[84:85], v[88:89]
    v_add_f32 v84, v84, v85
    v_mov_b32 v85, v84
    v_pk_add_f32 v[86:87], v[32:33], v[34:35]
    v_pk_add_f32 v[90:91], v[36:37], v[38:39]
    v_pk_add_f32 v[86:87], v[86:87], v[40:41]
    v_pk_add_f32 v[90:91], v[90:91], v[42:43]
    v_pk_add_f32 v[86:87], v[86:87], v[44:45]
    v_pk_add_f32 v[90:91], v[90:91], v[46:47]
    v_pk_add_f32 v[86:87], v[86:87], v[90:91]
    v_add_f32 v86, v86, v87
    v_mov_b32 v87, v86
    v_permlane32_swap_b32 v84, v85
    s_nop 0
    v_permlane32_swap_b32 v86, v87
    v_add_f32 v84, v84, v85
    v_add_f32 v86, v86, v87
    v_rcp_f32 v84, v84
    v_rcp_f32 v86, v86
    v_mov_b32 v85, v84
    v_mov_b32_e64 v87, v86
    v_pk_mul_f32 v[48:49], v[48:49], v[84:85]
    v_pk_mul_f32 v[32:33], v[32:33], v[86:87]
    v_pk_mul_f32 v[50:51], v[50:51], v[84:85]
    v_pk_mul_f32 v[34:35], v[34:35], v[86:87]
    v_pk_mul_f32 v[52:53], v[52:53], v[84:85]
    v_pk_mul_f32 v[36:37], v[36:37], v[86:87]
    v_pk_mul_f32 v[54:55], v[54:55], v[84:85]
    v_pk_mul_f32 v[38:39], v[38:39], v[86:87]
    v_pk_mul_f32 v[56:57], v[56:57], v[84:85]
    v_pk_mul_f32 v[40:41], v[40:41], v[86:87]
    v_pk_mul_f32 v[58:59], v[58:59], v[84:85]
    v_pk_mul_f32 v[42:43], v[42:43], v[86:87]
    v_pk_mul_f32 v[60:61], v[60:61], v[84:85]
    v_pk_mul_f32 v[44:45], v[44:45], v[86:87]
    v_pk_mul_f32 v[62:63], v[62:63], v[84:85]
    v_pk_mul_f32 v[46:47], v[46:47], v[86:87]
    v_cvt_pk_bf16_f32 v132, v48, v49
    v_cvt_pk_bf16_f32 v133, v50, v51
    v_cvt_pk_bf16_f32 v134, v52, v53
    v_cvt_pk_bf16_f32 v135, v54, v55
    v_cvt_pk_bf16_f32 v136, v56, v57
    v_cvt_pk_bf16_f32 v137, v58, v59
    v_cvt_pk_bf16_f32 v138, v60, v61
    v_cvt_pk_bf16_f32 v139, v62, v63
    v_cvt_pk_bf16_f32 v140, v32, v33
    v_cvt_pk_bf16_f32 v141, v34, v35
    v_cvt_pk_bf16_f32 v142, v36, v37
    v_cvt_pk_bf16_f32 v143, v38, v39
    v_cvt_pk_bf16_f32 v144, v40, v41
    v_cvt_pk_bf16_f32 v145, v42, v43
    v_cvt_pk_bf16_f32 v146, v44, v45
    v_cvt_pk_bf16_f32 v147, v46, v47
    v_mov_b32 v22, 156672
    s_cmp_lg_u32 s28, 0
    s_cbranch_scc1 L_s1_lds
    v_lshrrev_b32 v20, 2, v1
    v_lshlrev_b32 v20, 7, v20
    v_and_b32_e64 v21, 3, v1
    v_lshl_add_u32 v20, v21, 2, v20
    s_lshl_b32 s48, s29, 11
    s_nop 0
    s_add_u32 s48, s48, 29360128
    s_mov_b32 s53, 0
    s_nop 0
    buffer_load_dword v21, v20, s[20:23], s48 offen sc1
    s_waitcnt vmcnt(0)
    s_branch L_sp_kv_1c
L_sp_kv_1:
    s_sleep 2
    s_nop 0
    buffer_load_dword v21, v20, s[20:23], s48 offen sc1
    s_waitcnt vmcnt(0)
L_sp_kv_1c:
    v_cmp_eq_u32 vcc, s58, v21
    s_add_u32 s53, s53, 1
    s_and_b32 s50, vcc_lo, 0xffffffff
    s_and_b32 s51, vcc_hi, 0xffffffff
    s_and_b32 s50, s50, s51
    s_cmp_eq_u32 s50, -1
    s_cbranch_scc1 L_ok_kv_2
    s_cmp_lt_u32 s53, 400000
    s_cbranch_scc1 L_sp_kv_1
L_ok_kv_2:
    v_mov_b32 v21, s58
    ds_write_b32 v22, v21
    s_branch L_s1_done
L_s1_lds:
    s_mov_b32 s53, 0
L_s1_spin:
    s_sleep 1
    s_nop 0
    ds_read_b32 v21, v22
    s_add_u32 s53, s53, 1
    s_waitcnt lgkmcnt(0)
    v_readfirstlane_b32 s48, v21
    s_nop 0
    s_cmp_eq_u32 s48, s58
    s_cbranch_scc1 L_s1_done
    s_cmp_lt_u32 s53, 3200000
    s_cbranch_scc1 L_s1_spin
L_s1_done:
    s_lshl_b32 s49, s28, 11
    s_lshl_b32 s48, s29, 19
    s_add_u32 s48, s48, s49
    s_add_u32 s48, s48, 4194304
    s_add_u32 s24, s42, s48
    s_addc_u32 s25, s43, 0
    s_mov_b32 s26, 0x40000
    s_mov_b32 s27, 0x20000
    s_add_u32 s4, s24, 0x40000
    s_addc_u32 s5, s25, 0
    s_nop 0
    s_mov_b32 s6, 0x40000
    s_mov_b32 s7, 0x20000
    s_lshl_b32 s52, s30, 14
    s_nop 0
    s_add_u32 s52, s52, 16384
    s_and_b32 s52, s52, 0x3ffff
    s_add_u32 m0, s49, 32768
    s_nop 0
    s_nop 0
    buffer_load_dwordx4 v24, s[24:27], s52 offen  lds
    buffer_load_dwordx4 v24, s[24:27], s52 offen offset:1024  lds
    s_add_u32 m0, m0, 8192
    s_nop 0
    s_nop 0
    buffer_load_dwordx4 v24, s[4:7], s52 offen  lds
    buffer_load_dwordx4 v24, s[4:7], s52 offen offset:1024  lds
    s_add_u32 s52, s52, 8192
    s_and_b32 s52, s52, 0x3ffff
    s_add_u32 m0, s49, 49152
    s_nop 0
    s_nop 0
    buffer_load_dwordx4 v24, s[24:27], s52 offen  lds
    buffer_load_dwordx4 v24, s[24:27], s52 offen offset:1024  lds
    s_add_u32 m0, m0, 8192
    s_nop 0
    s_nop 0
    buffer_load_dwordx4 v24, s[4:7], s52 offen  lds
    buffer_load_dwordx4 v24, s[4:7], s52 offen offset:1024  lds
    s_add_u32 s52, s52, 8192
    s_and_b32 s52, s52, 0x3ffff
    s_add_u32 m0, s49, 65536
    s_nop 0
    s_nop 0
    buffer_load_dwordx4 v24, s[24:27], s52 offen  lds
    buffer_load_dwordx4 v24, s[24:27], s52 offen offset:1024  lds
    s_add_u32 m0, m0, 8192
    s_nop 0
    s_nop 0
    buffer_load_dwordx4 v24, s[4:7], s52 offen  lds
    buffer_load_dwordx4 v24, s[4:7], s52 offen offset:1024  lds
    s_add_u32 s52, s52, 8192
    s_and_b32 s52, s52, 0x3ffff
    s_add_u32 m0, s49, 81920
    s_nop 0
    s_nop 0
    buffer_load_dwordx4 v24, s[24:27], s52 offen  lds
    buffer_load_dwordx4 v24, s[24:27], s52 offen offset:1024  lds
    s_add_u32 m0, m0, 8192
    s_nop 0
    s_nop 0
    buffer_load_dwordx4 v24, s[4:7], s52 offen  lds
    buffer_load_dwordx4 v24, s[4:7], s52 offen offset:1024  lds
    s_waitcnt lgkmcnt(0)
    s_barrier
    s_branch L_trans
L_B:
    s_waitcnt lgkmcnt(0)
    s_mov_b32 s8, s4
    s_mov_b32 s9, s5
    s_mov_b32 s10, 0x400000
    s_mov_b32 s11, 0x20000
    s_mov_b32 s12, s6
    s_mov_b32 s13, s7
    s_mov_b32 s14, 0x600000
    s_mov_b32 s15, 0x20000
    s_mov_b32 s16, s40
    s_mov_b32 s17, s41
    s_mov_b32 s18, 0x600000
    s_mov_b32 s19, 0x20000
    s_mov_b32 s20, s42
    s_mov_b32 s21, s43
    s_mov_b32 s22, 0x10000000
    s_mov_b32 s23, 0x20000
    s_mov_b32 s4, s42
    s_mov_b32 s5, s43
    s_mov_b32 s6, 0x40000
    s_mov_b32 s7, 0x20000
    s_mov_b32 s24, s42
    s_mov_b32 s25, s43
    s_mov_b32 s26, 0x40000
    s_mov_b32 s27, 0x20000
    s_cmp_lg_u32 s2, 0
    s_cbranch_scc1 L_notag
    s_cmp_lg_u32 s28, 7
    s_cbranch_scc1 L_notag
    s_mov_b32 s24, s86
    s_mov_b32 s25, s87
    s_mov_b32 s26, 0x100
    s_mov_b32 s27, 0x20000
    s_memrealtime s[48:49]
    s_waitcnt lgkmcnt(0)
    s_or_b32 s48, s48, 1
    v_mov_b32 v20, 0
    v_mov_b32 v21, s48
    v_cmp_eq_u32 vcc, 0, v1
    s_and_saveexec_b64 s[50:51], vcc
    buffer_store_dword v21, v20, s[24:27], 0 offen sc1
    s_mov_b64 exec, s[50:51]
L_notag:
    s_cmp_lg_u32 s28, 7
    s_cbranch_scc1 L_notlb
    s_lshr_b32 s48, s2, 3
    s_mul_i32 s48, s48, 11
    v_add_u32 v20, s48, v1
    v_lshlrev_b32_e64 v21, 16, v20
    v_add_u32 v22, 4194304, v21
    v_add_u32 v23, 12582912, v21
    v_cmp_gt_u32 vcc, 128, v20
    s_nop 1
    v_cndmask_b32 v22, v23, v22, vcc
    v_add_u32 v23, 20971520, v21
    v_cmp_gt_u32 vcc, 192, v20
    s_nop 1
    v_cndmask_b32 v22, v23, v22, vcc
    v_subrev_u32 v23, 320, v20
    v_lshlrev_b32_e64 v23, 20, v23
    v_add_u32 v23, 25165824, v23
    v_cmp_gt_u32 vcc, 320, v20
    s_nop 1
    v_cndmask_b32 v22, v23, v22, vcc
    v_cmp_gt_u32 vcc, 325, v20
    v_cmp_gt_u32 s[50:51], 11, v1
    s_and_b64 vcc, vcc, s[50:51]
    s_and_saveexec_b64 s[52:53], vcc
    s_cbranch_execz L_tlb2
    s_nop 0
    buffer_load_dword v209, v22, s[20:23], 0 offen sc1
L_tlb2:
    s_mov_b64 exec, s[52:53]
    s_mov_b32 s24, s80
    s_mov_b32 s25, s81
    s_nop 0
    s_mov_b32 s26, 0x400000
    s_mov_b32 s27, 0x20000
    s_lshr_b32 s48, s2, 3
    s_lshl_b32 s48, s48, 17
    v_and_b32 v20, 1, v1
    v_lshlrev_b32 v20, 16, v20
    buffer_load_dword v211, v20, s[24:27], s48 offen
L_notlb:
    s_cmp_lg_u32 s28, 4
    s_cbranch_scc1 L_nomisc
    v_lshlrev_b32_e64 v20, 4, v1
    s_mov_b32 s24, s54
    s_mov_b32 s25, s55
    s_mov_b32 s26, 0x10000
    s_mov_b32 s27, 0x20000
    s_lshl_b32 s48, s29, 12
    s_nop 0
    s_mov_b32 m0, 149504
    s_nop 0
    s_nop 0
    buffer_load_dwordx4 v20, s[24:27], s48 offen lds
    buffer_load_dwordx4 v20, s[24:27], s48 offen offset:1024 lds
    buffer_load_dwordx4 v20, s[24:27], s48 offen offset:2048 lds
    buffer_load_dwordx4 v20, s[24:27], s48 offen offset:3072 lds
L_nomisc:
    s_lshl_b32 s48, s30, 7
    s_lshl_b32 s49, s29, 3
    s_add_u32 s48, s48, s49
    s_sub_u32 s49, s28, 4
    s_lshl_b32 s49, s49, 1
    s_add_u32 s52, s48, s49
    s_lshl_b32 s48, s52, 11
    v_lshlrev_b32 v20, 5, v1
    buffer_load_dwordx4 v[128:131], v20, s[8:11], s48 offen
    buffer_load_dwordx4 v[132:135], v20, s[8:11], s48 offen offset:16
    buffer_load_dwordx4 v[136:139], v20, s[8:11], s48 offen offset:2048
    buffer_load_dwordx4 v[140:143], v20, s[8:11], s48 offen offset:2064
    s_mov_b32 s24, s56
    s_mov_b32 s25, s57
    s_mov_b32 s26, 0x800
    s_mov_b32 s27, 0x20000
    buffer_load_dwordx4 v[144:147], v20, s[24:27], 0 offen
    buffer_load_dwordx4 v[148:151], v20, s[24:27], 0 offen offset:16
    s_sub_u32 s48, s28, 4
    s_lshl_b32 s48, s48, 3
    v_and_b32 v20, 7, v1
    v_add_u32 v20, s48, v20
    s_mul_i32 s48, s2, 12
    v_add_u32 v21, s48, v20
    v_subrev_u32 v22, 12, v21
    v_cmp_gt_u32 vcc, 12, v20
    s_nop 1
    v_cndmask_b32 v21, v22, v21, vcc
    v_lshlrev_b32 v21, 7, v21
    v_mov_b32 v26, s40
    v_mov_b32 v27, s41
    v_mov_b32 v28, s12
    v_mov_b32 v29, s13
    v_cndmask_b32 v26, v26, v28, vcc
    v_cndmask_b32 v27, v27, v29, vcc
    s_lshl_b32 s48, s2, 3
    v_subrev_u32 v22, 24, v20
    v_add_u32 v22, s48, v22
    v_lshlrev_b32 v22, 11, v22
    v_cmp_gt_u32 vcc, 24, v20
    s_nop 1
    v_cndmask_b32 v21, v22, v21, vcc
    v_mov_b32 v28, s8
    v_mov_b32 v29, s9
    v_cndmask_b32 v26, v28, v26, vcc
    v_cndmask_b32 v27, v29, v27, vcc
    v_mov_b32 v28, 128
    v_mov_b32 v29, 393216
    v_cndmask_b32 v210, v28, v29, vcc
    v_mul_u32_u24 v28, 2, v210
    v_add_u32_e64 v21, v21, v28
    v_add_co_u32 v26, s[50:51], v26, v21
    s_nop 1
    s_nop 0
    v_addc_co_u32 v27, s[50:51], 0, v27, s[50:51]
    s_barrier
    s_mov_b32 s16, s86
    s_mov_b32 s17, s87
    s_nop 0
    s_mov_b32 s18, 0x100
    s_mov_b32 s19, 0x20000
    s_mov_b32 s34, 0
    s_nop 0
    s_mov_b32 s35, 24576
    s_mov_b32 s36, 32768
    s_mov_b32 s37, 16384
    v_mov_b32 v18, v16
    v_mov_b32 v14, v10
    v_mov_b32 v19, v17
    v_mov_b32 v15, v11
    v_mov_b64 v[32:33], 0
    v_mov_b64 v[34:35], 0
    v_mov_b64 v[36:37], 0
    v_mov_b64 v[38:39], 0
    v_mov_b64 v[40:41], 0
    v_mov_b64 v[42:43], 0
    v_mov_b64 v[44:45], 0
    v_mov_b64 v[46:47], 0
    v_mov_b64 v[48:49], 0
    v_mov_b64 v[50:51], 0
    v_mov_b64 v[52:53], 0
    v_mov_b64 v[54:55], 0
    v_mov_b64 v[56:57], 0
    v_mov_b64 v[58:59], 0
    v_mov_b64 v[60:61], 0
    v_mov_b64 v[62:63], 0
    v_mov_b64 v[64:65], 0
    v_mov_b64 v[66:67], 0
    v_mov_b64 v[68:69], 0
    v_mov_b64 v[70:71], 0
    v_mov_b64 v[72:73], 0
    v_mov_b64 v[74:75], 0
    v_mov_b64 v[76:77], 0
    v_mov_b64 v[78:79], 0
    v_mov_b64 v[80:81], 0
    v_mov_b64 v[82:83], 0
    v_mov_b64 v[84:85], 0
    v_mov_b64 v[86:87], 0
    v_mov_b64 v[88:89], 0
    v_mov_b64 v[90:91], 0
    v_mov_b64 v[92:93], 0
    v_mov_b64 v[94:95], 0
    v_mov_b64 v[96:97], 0
    v_mov_b64 v[98:99], 0
    v_mov_b64 v[100:101], 0
    v_mov_b64 v[102:103], 0
    v_mov_b64 v[104:105], 0
    v_mov_b64 v[106:107], 0
    v_mov_b64 v[108:109], 0
    v_mov_b64 v[110:111], 0
    v_mov_b64 v[112:113], 0
    v_mov_b64 v[114:115], 0
    v_mov_b64 v[116:117], 0
    v_mov_b64 v[118:119], 0
    v_mov_b64 v[120:121], 0
    v_mov_b64 v[122:123], 0
    v_mov_b64 v[124:125], 0
    v_mov_b64 v[126:127], 0
    v_and_b32 v20, 31, v1
    v_lshrrev_b32 v21, 5, v1
    v_lshlrev_b32 v21, 2, v21
    v_sub_u32 v20, v20, v21
    v_mov_b32 v22, 0x3f80
    v_mov_b32 v21, 0x3f800000
    v_cmp_eq_u32 vcc, 0, v20
    s_nop 1
    v_cndmask_b32 v216, 0, v22, vcc
    v_cmp_eq_u32 vcc, 1, v20
    s_nop 1
    v_cndmask_b32 v216, v216, v21, vcc
    v_cmp_eq_u32 vcc, 2, v20
    s_nop 1
    v_cndmask_b32 v217, 0, v22, vcc
    v_cmp_eq_u32 vcc, 3, v20
    s_nop 1
    v_cndmask_b32 v217, v217, v21, vcc
    v_cmp_eq_u32 vcc, 8, v20
    s_nop 1
    v_cndmask_b32 v218, 0, v22, vcc
    v_cmp_eq_u32 vcc, 9, v20
    s_nop 1
    v_cndmask_b32 v218, v218, v21, vcc
    v_cmp_eq_u32 vcc, 10, v20
    s_nop 1
    v_cndmask_b32 v219, 0, v22, vcc
    v_cmp_eq_u32 vcc, 11, v20
    s_nop 1
    v_cndmask_b32 v219, v219, v21, vcc
    v_cmp_eq_u32 vcc, 16, v20
    s_nop 1
    v_cndmask_b32 v220, 0, v22, vcc
    v_cmp_eq_u32 vcc, 17, v20
    s_nop 1
    v_cndmask_b32 v220, v220, v21, vcc
    v_cmp_eq_u32 vcc, 18, v20
    s_nop 1
    v_cndmask_b32 v221, 0, v22, vcc
    v_cmp_eq_u32 vcc, 19, v20
    s_nop 1
    v_cndmask_b32 v221, v221, v21, vcc
    v_cmp_eq_u32 vcc, 24, v20
    s_nop 1
    v_cndmask_b32 v222, 0, v22, vcc
    v_cmp_eq_u32 vcc, 25, v20
    s_nop 1
    v_cndmask_b32 v222, v222, v21, vcc
    v_cmp_eq_u32 vcc, 26, v20
    s_nop 1
    v_cndmask_b32 v223, 0, v22, vcc
    v_cmp_eq_u32 vcc, 27, v20
    s_nop 1
    v_cndmask_b32 v223, v223, v21, vcc
    s_waitcnt vmcnt(0)
    v_mov_b32 v30, 0
    v_mov_b32 v31, 0
    v_dot2_f32_bf16 v30, v128, v144, v30
    v_dot2_f32_bf16 v31, v136, v144, v31
    v_dot2_f32_bf16 v30, v129, v145, v30
    v_dot2_f32_bf16 v31, v137, v145, v31
    v_dot2_f32_bf16 v30, v130, v146, v30
    v_dot2_f32_bf16 v31, v138, v146, v31
    v_dot2_f32_bf16 v30, v131, v147, v30
    v_dot2_f32_bf16 v31, v139, v147, v31
    v_dot2_f32_bf16 v30, v132, v148, v30
    v_dot2_f32_bf16 v31, v140, v148, v31
    v_dot2_f32_bf16 v30, v133, v149, v30
    v_dot2_f32_bf16 v31, v141, v149, v31
    v_dot2_f32_bf16 v30, v134, v150, v30
    v_dot2_f32_bf16 v31, v142, v150, v31
    v_dot2_f32_bf16 v30, v135, v151, v30
    v_dot2_f32_bf16 v31, v143, v151, v31
    s_nop 1
    s_nop 0
    v_add_f32_dpp v30, v30, v30 row_ror:1 row_mask:0xf bank_mask:0xf
    v_add_f32_dpp v31, v31, v31 row_ror:1 row_mask:0xf bank_mask:0xf
    s_nop 0
    s_nop 0
    v_add_f32_dpp v30, v30, v30 row_ror:2 row_mask:0xf bank_mask:0xf
    v_add_f32_dpp v31, v31, v31 row_ror:2 row_mask:0xf bank_mask:0xf
    s_nop 0
    s_nop 0
    v_add_f32_dpp v30, v30, v30 row_ror:4 row_mask:0xf bank_mask:0xf
    v_add_f32_dpp v31, v31, v31 row_ror:4 row_mask:0xf bank_mask:0xf
    s_nop 0
    s_nop 0
    v_add_f32_dpp v30, v30, v30 row_ror:8 row_mask:0xf bank_mask:0xf
    v_add_f32_dpp v31, v31, v31 row_ror:8 row_mask:0xf bank_mask:0xf
    v_mov_b32 v20, v30
    v_mov_b32 v21, v31
    s_nop 0
    v_permlane16_swap_b32 v30, v20
    v_permlane16_swap_b32 v31, v21
    v_add_f32 v30, v30, v20
    v_add_f32 v31, v31, v21
    v_mov_b32 v20, v30
    v_mov_b32 v21, v31
    s_nop 0
    v_permlane32_swap_b32 v30, v20
    v_permlane32_swap_b32 v31, v21
    v_add_f32 v30, v30, v20
    v_add_f32 v31, v31, v21
    s_mov_b32 s53, 0x3fb8aa3b
    v_mul_f32 v30, s53, v30
    v_mul_f32 v31, s53, v31
    v_exp_f32 v30, -v30
    v_exp_f32 v31, -v31
    v_add_f32 v30, 1.0, v30
    v_add_f32 v31, 1.0, v31
    v_rcp_f32 v30, v30
    v_rcp_f32_e64 v31, v31
    s_lshl_b32 s48, s52, 2
    s_add_u32 s48, s48, 26214400
    v_mov_b32_e64 v20, 0
    v_cmp_eq_u32 vcc, 0, v1
    s_and_saveexec_b64 s[50:51], vcc
    buffer_store_dwordx2 v[30:31], v20, s[20:23], s48 offen sc1
    s_mov_b64 exec, s[50:51]
    s_barrier
    ds_read_b128 v[128:131], v14 offset:0
    ds_read_b128 v[132:135], v14 offset:2048
    ds_read_b128 v[136:139], v14 offset:4096
    ds_read_b128 v[140:143], v14 offset:6144
    ds_read_b64_tr_b16 v[160:161], v18 offset:0
    ds_read_b64_tr_b16 v[162:163], v18 offset:512
    ds_read_b64_tr_b16 v[164:165], v19 offset:0
    ds_read_b64_tr_b16 v[166:167], v19 offset:512
    ds_read_b64_tr_b16 v[168:169], v18 offset:4096
    ds_read_b64_tr_b16 v[170:171], v18 offset:4608
    v_lshrrev_b32 v20, 5, v1
    v_lshlrev_b32 v20, 3, v20
    v_bfe_u32 v21, v1, 2, 2
    v_add_u32 v20, v20, v21
    v_lshlrev_b32 v20, 6, v20
    v_bfe_u32 v21, v1, 4, 1
    v_lshl_add_u32 v20, v21, 5, v20
    v_and_b32_e64 v21, 3, v1
    v_lshl_add_u32 v20, v21, 3, v20
    s_lshl_b32 s48, s32, 11
    s_nop 0
    s_add_u32 s48, s48, 149504
    v_add_u32_e64 v20, s48, v20
    ds_read_b64_tr_b16 v[2:3], v20
    ds_read_b64_tr_b16 v[4:5], v20 offset:256
    ds_read_b64_tr_b16 v[6:7], v20 offset:1024
    ds_read_b64_tr_b16 v[8:9], v20 offset:1280
    global_load_dword v208, v[26:27], off
    v_add_co_u32 v26, vcc, v26, v210
    s_nop 1
    v_addc_co_u32 v27, vcc, 0, v27, vcc
    s_nop 0
    global_load_dword v208, v[26:27], off
    v_add_co_u32 v26, vcc, v26, v210
    s_nop 1
    v_addc_co_u32 v27, vcc, 0, v27, vcc
    s_waitcnt lgkmcnt(0)
    s_mov_b32 s44, 13
L_loop_B:
    s_cmp_lt_u32 s44, 2
    s_cbranch_scc1 L_notouch
    s_nop 0
    global_load_dword v208, v[26:27], off
    v_add_co_u32 v26, vcc, v26, v210
    s_nop 1
    v_addc_co_u32 v27, vcc, 0, v27, vcc
L_notouch:
    s_nop 0
    v_mfma_f32_16x16x32_bf16 v[32:35], v[160:163], v[128:131], v[32:35]
    ds_read_b64_tr_b16 v[172:173], v19 offset:4096
    v_mfma_f32_16x16x32_bf16 v[36:39], v[160:163], v[132:135], v[36:39]
    v_mfma_f32_16x16x32_bf16 v[40:43], v[160:163], v[136:139], v[40:43]
    ds_read_b64_tr_b16 v[174:175], v19 offset:4608
    v_mfma_f32_16x16x32_bf16 v[44:47], v[160:163], v[140:143], v[44:47]
    v_mfma_f32_16x16x32_bf16 v[48:51], v[164:167], v[128:131], v[48:51]
    ds_read_b64_tr_b16 v[176:177], v18 offset:8192
    v_mfma_f32_16x16x32_bf16 v[52:55], v[164:167], v[132:135], v[52:55]
    v_mfma_f32_16x16x32_bf16 v[56:59], v[164:167], v[136:139], v[56:59]
    ds_read_b64_tr_b16 v[178:179], v18 offset:8704
    v_mfma_f32_16x16x32_bf16 v[60:63], v[164:167], v[140:143], v[60:63]
    v_mfma_f32_16x16x32_bf16 v[64:67], v[168:171], v[128:131], v[64:67]
    ds_read_b64_tr_b16 v[180:181], v19 offset:8192
    v_mfma_f32_16x16x32_bf16 v[68:71], v[168:171], v[132:135], v[68:71]
    v_mfma_f32_16x16x32_bf16 v[72:75], v[168:171], v[136:139], v[72:75]
    ds_read_b64_tr_b16 v[182:183], v19 offset:8704
    v_mfma_f32_16x16x32_bf16 v[76:79], v[168:171], v[140:143], v[76:79]
    s_waitcnt lgkmcnt(0)
    s_nop 0
    v_mfma_f32_16x16x32_bf16 v[80:83], v[172:175], v[128:131], v[80:83]
    v_add_u32_e64 v18, s35, v16
    v_mfma_f32_16x16x32_bf16 v[84:87], v[172:175], v[132:135], v[84:87]
    v_mfma_f32_16x16x32_bf16 v[88:91], v[172:175], v[136:139], v[88:91]
    v_add_u32_e64 v19, s35, v17
    v_mfma_f32_16x16x32_bf16 v[92:95], v[172:175], v[140:143], v[92:95]
    s_barrier
    s_nop 0
    v_mfma_f32_16x16x32_bf16 v[96:99], v[128:131], v[176:179], v[96:99]
    ds_read_b128 v[144:147], v15 offset:0
    ds_read_b64_tr_b16 v[160:161], v18 offset:0
    v_mfma_f32_16x16x32_bf16 v[100:103], v[132:135], v[176:179], v[100:103]
    ds_read_b64_tr_b16 v[162:163], v18 offset:512
    ds_read_b128 v[148:151], v15 offset:2048
    v_mfma_f32_16x16x32_bf16 v[104:107], v[136:139], v[176:179], v[104:107]
    ds_read_b64_tr_b16 v[164:165], v19 offset:0
    ds_read_b64_tr_b16 v[166:167], v19 offset:512
    v_mfma_f32_16x16x32_bf16 v[108:111], v[140:143], v[176:179], v[108:111]
    ds_read_b128 v[152:155], v15 offset:4096
    ds_read_b64_tr_b16 v[168:169], v18 offset:4096
    v_mfma_f32_16x16x32_bf16 v[112:115], v[128:131], v[180:183], v[112:115]
    ds_read_b64_tr_b16 v[170:171], v18 offset:4608
    ds_read_b128 v[156:159], v15 offset:6144
    v_mfma_f32_16x16x32_bf16 v[116:119], v[132:135], v[180:183], v[116:119]
    s_mov_b32 s3, s34
    s_mov_b32 s34, s35
    v_mfma_f32_16x16x32_bf16 v[120:123], v[136:139], v[180:183], v[120:123]
    s_add_u32 s35, s35, 24576
    s_cmp_eq_u32 s35, 98304
    v_mfma_f32_16x16x32_bf16 v[124:127], v[140:143], v[180:183], v[124:127]
    s_cselect_b32 s35, 0, s35
    s_waitcnt lgkmcnt(0)
    v_mfma_f32_16x16x32_bf16 v[32:35], v[160:163], v[144:147], v[32:35]
    ds_read_b64_tr_b16 v[172:173], v19 offset:4096
    v_mfma_f32_16x16x32_bf16 v[36:39], v[160:163], v[148:151], v[36:39]
    v_mfma_f32_16x16x32_bf16 v[40:43], v[160:163], v[152:155], v[40:43]
    ds_read_b64_tr_b16 v[174:175], v19 offset:4608
    v_mfma_f32_16x16x32_bf16 v[44:47], v[160:163], v[156:159], v[44:47]
    v_mfma_f32_16x16x32_bf16 v[48:51], v[164:167], v[144:147], v[48:51]
    ds_read_b64_tr_b16 v[176:177], v18 offset:8192
    v_mfma_f32_16x16x32_bf16 v[52:55], v[164:167], v[148:151], v[52:55]
    v_mfma_f32_16x16x32_bf16 v[56:59], v[164:167], v[152:155], v[56:59]
    ds_read_b64_tr_b16 v[178:179], v18 offset:8704
    v_mfma_f32_16x16x32_bf16 v[60:63], v[164:167], v[156:159], v[60:63]
    v_mfma_f32_16x16x32_bf16 v[64:67], v[168:171], v[144:147], v[64:67]
    ds_read_b64_tr_b16 v[180:181], v19 offset:8192
    v_mfma_f32_16x16x32_bf16 v[68:71], v[168:171], v[148:151], v[68:71]
    v_mfma_f32_16x16x32_bf16 v[72:75], v[168:171], v[152:155], v[72:75]
    ds_read_b64_tr_b16 v[182:183], v19 offset:8704
    v_mfma_f32_16x16x32_bf16 v[76:79], v[168:171], v[156:159], v[76:79]
    s_waitcnt lgkmcnt(0)
    s_nop 0
    v_mfma_f32_16x16x32_bf16 v[80:83], v[172:175], v[144:147], v[80:83]
    v_add_u32_e64 v18, s35, v16
    v_mfma_f32_16x16x32_bf16 v[84:87], v[172:175], v[148:151], v[84:87]
    v_add_u32_e64 v19, s35, v17
    v_mfma_f32_16x16x32_bf16 v[88:91], v[172:175], v[152:155], v[88:91]
    v_add_u32_e64 v14, s37, v10
    v_mfma_f32_16x16x32_bf16 v[92:95], v[172:175], v[156:159], v[92:95]
    v_add_u32 v15, s37, v11
    s_barrier
    v_mfma_f32_16x16x32_bf16 v[96:99], v[144:147], v[176:179], v[96:99]
    ds_read_b128 v[128:131], v14 offset:0
    ds_read_b64_tr_b16 v[160:161], v18 offset:0
    ds_read_b64_tr_b16 v[162:163], v18 offset:512
    v_mfma_f32_16x16x32_bf16 v[100:103], v[148:151], v[176:179], v[100:103]
    ds_read_b128 v[132:135], v14 offset:2048
    ds_read_b64_tr_b16 v[164:165], v19 offset:0
    v_mfma_f32_16x16x32_bf16 v[104:107], v[152:155], v[176:179], v[104:107]
    ds_read_b64_tr_b16 v[166:167], v19 offset:512
    ds_read_b128 v[136:139], v14 offset:4096
    v_mfma_f32_16x16x32_bf16 v[108:111], v[156:159], v[176:179], v[108:111]
    ds_read_b64_tr_b16 v[168:169], v18 offset:4096
    ds_read_b64_tr_b16 v[170:171], v18 offset:4608
    v_mfma_f32_16x16x32_bf16 v[112:115], v[144:147], v[180:183], v[112:115]
    ds_read_b128 v[140:143], v14 offset:6144
    s_mov_b32 s3, s34
    s_mov_b32 s34, s35
    v_mfma_f32_16x16x32_bf16 v[116:119], v[148:151], v[180:183], v[116:119]
    s_add_u32 s35, s35, 24576
    s_cmp_eq_u32 s35, 98304
    v_mfma_f32_16x16x32_bf16 v[120:123], v[152:155], v[180:183], v[120:123]
    s_cselect_b32 s35, 0, s35
    s_nop 0
    s_add_u32 s37, s37, 16384
    v_mfma_f32_16x16x32_bf16 v[124:127], v[156:159], v[180:183], v[124:127]
    s_cmp_eq_u32 s37, 49152
    s_cselect_b32 s37, 0, s37
    s_waitcnt lgkmcnt(0)
    s_sub_u32 s44, s44, 1
    s_cmp_lg_u32 s44, 0
    s_cbranch_scc1 L_loop_B
    v_mov_b32 v20, 0
    buffer_load_dword v25, v20, s[16:19], 0 offen sc1
    v_mfma_f32_16x16x32_bf16 v[32:35], v[160:163], v[128:131], v[32:35]
    ds_read_b64_tr_b16 v[172:173], v19 offset:4096
    v_mfma_f32_16x16x32_bf16 v[36:39], v[160:163], v[132:135], v[36:39]
    v_mfma_f32_16x16x32_bf16 v[40:43], v[160:163], v[136:139], v[40:43]
    ds_read_b64_tr_b16 v[174:175], v19 offset:4608
    v_mfma_f32_16x16x32_bf16 v[44:47], v[160:163], v[140:143], v[44:47]
    v_mfma_f32_16x16x32_bf16 v[48:51], v[164:167], v[128:131], v[48:51]
    ds_read_b64_tr_b16 v[176:177], v18 offset:8192
    v_mfma_f32_16x16x32_bf16 v[52:55], v[164:167], v[132:135], v[52:55]
    v_mfma_f32_16x16x32_bf16 v[56:59], v[164:167], v[136:139], v[56:59]
    ds_read_b64_tr_b16 v[178:179], v18 offset:8704
    v_mfma_f32_16x16x32_bf16 v[60:63], v[164:167], v[140:143], v[60:63]
    v_mfma_f32_16x16x32_bf16 v[64:67], v[168:171], v[128:131], v[64:67]
    ds_read_b64_tr_b16 v[180:181], v19 offset:8192
    v_mfma_f32_16x16x32_bf16 v[68:71], v[168:171], v[132:135], v[68:71]
    v_mfma_f32_16x16x32_bf16 v[72:75], v[168:171], v[136:139], v[72:75]
    ds_read_b64_tr_b16 v[182:183], v19 offset:8704
    v_mfma_f32_16x16x32_bf16 v[76:79], v[168:171], v[140:143], v[76:79]
    s_waitcnt lgkmcnt(0)
    s_nop 0
    v_mfma_f32_16x16x32_bf16 v[80:83], v[172:175], v[128:131], v[80:83]
    v_add_u32_e64 v18, s35, v16
    v_mfma_f32_16x16x32_bf16 v[84:87], v[172:175], v[132:135], v[84:87]
    v_mfma_f32_16x16x32_bf16 v[88:91], v[172:175], v[136:139], v[88:91]
    v_add_u32_e64 v19, s35, v17
    v_mfma_f32_16x16x32_bf16 v[92:95], v[172:175], v[140:143], v[92:95]
    s_barrier
    s_nop 0
    v_mfma_f32_16x16x32_bf16 v[96:99], v[128:131], v[176:179], v[96:99]
    ds_read_b128 v[144:147], v15 offset:0
    ds_read_b64_tr_b16 v[160:161], v18 offset:0
    v_mfma_f32_16x16x32_bf16 v[100:103], v[132:135], v[176:179], v[100:103]
    ds_read_b64_tr_b16 v[162:163], v18 offset:512
    ds_read_b128 v[148:151], v15 offset:2048
    v_mfma_f32_16x16x32_bf16 v[104:107], v[136:139], v[176:179], v[104:107]
    ds_read_b64_tr_b16 v[164:165], v19 offset:0
    ds_read_b64_tr_b16 v[166:167], v19 offset:512
    v_mfma_f32_16x16x32_bf16 v[108:111], v[140:143], v[176:179], v[108:111]
    ds_read_b128 v[152:155], v15 offset:4096
    ds_read_b64_tr_b16 v[168:169], v18 offset:4096
    v_mfma_f32_16x16x32_bf16 v[112:115], v[128:131], v[180:183], v[112:115]
    ds_read_b64_tr_b16 v[170:171], v18 offset:4608
    ds_read_b128 v[156:159], v15 offset:6144
    v_mfma_f32_16x16x32_bf16 v[116:119], v[132:135], v[180:183], v[116:119]
    s_mov_b32 s3, s34
    s_mov_b32 s34, s35
    v_mfma_f32_16x16x32_bf16 v[120:123], v[136:139], v[180:183], v[120:123]
    s_add_u32 s35, s35, 24576
    s_cmp_eq_u32 s35, 98304
    v_mfma_f32_16x16x32_bf16 v[124:127], v[140:143], v[180:183], v[124:127]
    s_cselect_b32 s35, 0, s35
    s_waitcnt lgkmcnt(0)
    v_mfma_f32_16x16x32_bf16 v[32:35], v[160:163], v[144:147], v[32:35]
    ds_read_b64_tr_b16 v[172:173], v19 offset:4096
    v_mfma_f32_16x16x32_bf16 v[36:39], v[160:163], v[148:151], v[36:39]
    v_mfma_f32_16x16x32_bf16 v[40:43], v[160:163], v[152:155], v[40:43]
    ds_read_b64_tr_b16 v[174:175], v19 offset:4608
    v_mfma_f32_16x16x32_bf16 v[44:47], v[160:163], v[156:159], v[44:47]
    v_mfma_f32_16x16x32_bf16 v[48:51], v[164:167], v[144:147], v[48:51]
    ds_read_b64_tr_b16 v[176:177], v18 offset:8192
    v_mfma_f32_16x16x32_bf16 v[52:55], v[164:167], v[148:151], v[52:55]
    v_mfma_f32_16x16x32_bf16 v[56:59], v[164:167], v[152:155], v[56:59]
    ds_read_b64_tr_b16 v[178:179], v18 offset:8704
    v_mfma_f32_16x16x32_bf16 v[60:63], v[164:167], v[156:159], v[60:63]
    v_mfma_f32_16x16x32_bf16 v[64:67], v[168:171], v[144:147], v[64:67]
    ds_read_b64_tr_b16 v[180:181], v19 offset:8192
    v_mfma_f32_16x16x32_bf16 v[68:71], v[168:171], v[148:151], v[68:71]
    v_mfma_f32_16x16x32_bf16 v[72:75], v[168:171], v[152:155], v[72:75]
    ds_read_b64_tr_b16 v[182:183], v19 offset:8704
    v_mfma_f32_16x16x32_bf16 v[76:79], v[168:171], v[156:159], v[76:79]
    s_waitcnt lgkmcnt(0)
    s_nop 0
    v_mfma_f32_16x16x32_bf16 v[80:83], v[172:175], v[144:147], v[80:83]
    v_add_u32_e64 v18, s35, v16
    v_mfma_f32_16x16x32_bf16 v[84:87], v[172:175], v[148:151], v[84:87]
    v_add_u32_e64 v19, s35, v17
    v_mfma_f32_16x16x32_bf16 v[88:91], v[172:175], v[152:155], v[88:91]
    v_add_u32_e64 v14, s37, v10
    v_mfma_f32_16x16x32_bf16 v[92:95], v[172:175], v[156:159], v[92:95]
    v_add_u32 v15, s37, v11
    s_barrier
    v_mfma_f32_16x16x32_bf16 v[96:99], v[144:147], v[176:179], v[96:99]
    ds_read_b128 v[128:131], v14 offset:0
    ds_read_b64_tr_b16 v[160:161], v18 offset:0
    ds_read_b64_tr_b16 v[162:163], v18 offset:512
    v_mfma_f32_16x16x32_bf16 v[100:103], v[148:151], v[176:179], v[100:103]
    ds_read_b128 v[132:135], v14 offset:2048
    ds_read_b64_tr_b16 v[164:165], v19 offset:0
    v_mfma_f32_16x16x32_bf16 v[104:107], v[152:155], v[176:179], v[104:107]
    ds_read_b64_tr_b16 v[166:167], v19 offset:512
    ds_read_b128 v[136:139], v14 offset:4096
    v_mfma_f32_16x16x32_bf16 v[108:111], v[156:159], v[176:179], v[108:111]
    ds_read_b64_tr_b16 v[168:169], v18 offset:4096
    ds_read_b64_tr_b16 v[170:171], v18 offset:4608
    v_mfma_f32_16x16x32_bf16 v[112:115], v[144:147], v[180:183], v[112:115]
    ds_read_b128 v[140:143], v14 offset:6144
    s_mov_b32 s3, s34
    s_mov_b32 s34, s35
    v_mfma_f32_16x16x32_bf16 v[116:119], v[148:151], v[180:183], v[116:119]
    s_add_u32 s35, s35, 24576
    s_cmp_eq_u32 s35, 98304
    v_mfma_f32_16x16x32_bf16 v[120:123], v[152:155], v[180:183], v[120:123]
    s_cselect_b32 s35, 0, s35
    s_nop 0
    s_add_u32 s37, s37, 16384
    v_mfma_f32_16x16x32_bf16 v[124:127], v[156:159], v[180:183], v[124:127]
    s_cmp_eq_u32 s37, 49152
    s_cselect_b32 s37, 0, s37
    s_waitcnt lgkmcnt(0)
    v_mfma_f32_16x16x32_bf16 v[32:35], v[160:163], v[128:131], v[32:35]
    ds_read_b64_tr_b16 v[172:173], v19 offset:4096
    v_mfma_f32_16x16x32_bf16 v[36:39], v[160:163], v[132:135], v[36:39]
    v_mfma_f32_16x16x32_bf16 v[40:43], v[160:163], v[136:139], v[40:43]
    ds_read_b64_tr_b16 v[174:175], v19 offset:4608
    v_mfma_f32_16x16x32_bf16 v[44:47], v[160:163], v[140:143], v[44:47]
    v_mfma_f32_16x16x32_bf16 v[48:51], v[164:167], v[128:131], v[48:51]
    ds_read_b64_tr_b16 v[176:177], v18 offset:8192
    v_mfma_f32_16x16x32_bf16 v[52:55], v[164:167], v[132:135], v[52:55]
    v_mfma_f32_16x16x32_bf16 v[56:59], v[164:167], v[136:139], v[56:59]
    ds_read_b64_tr_b16 v[178:179], v18 offset:8704
    v_mfma_f32_16x16x32_bf16 v[60:63], v[164:167], v[140:143], v[60:63]
    v_mfma_f32_16x16x32_bf16 v[64:67], v[168:171], v[128:131], v[64:67]
    ds_read_b64_tr_b16 v[180:181], v19 offset:8192
    v_mfma_f32_16x16x32_bf16 v[68:71], v[168:171], v[132:135], v[68:71]
    v_mfma_f32_16x16x32_bf16 v[72:75], v[168:171], v[136:139], v[72:75]
    ds_read_b64_tr_b16 v[182:183], v19 offset:8704
    v_mfma_f32_16x16x32_bf16 v[76:79], v[168:171], v[140:143], v[76:79]
    s_waitcnt lgkmcnt(0)
    s_nop 0
    v_mfma_f32_16x16x32_bf16 v[80:83], v[172:175], v[128:131], v[80:83]
    v_add_u32_e64 v18, s35, v16
    v_mfma_f32_16x16x32_bf16 v[84:87], v[172:175], v[132:135], v[84:87]
    v_mfma_f32_16x16x32_bf16 v[88:91], v[172:175], v[136:139], v[88:91]
    v_add_u32_e64 v19, s35, v17
    v_mfma_f32_16x16x32_bf16 v[92:95], v[172:175], v[140:143], v[92:95]
    s_barrier
    s_nop 0
    v_mfma_f32_16x16x32_bf16 v[96:99], v[128:131], v[176:179], v[96:99]
    ds_read_b128 v[144:147], v15 offset:0
    ds_read_b64_tr_b16 v[160:161], v18 offset:0
    v_mfma_f32_16x16x32_bf16 v[100:103], v[132:135], v[176:179], v[100:103]
    ds_read_b64_tr_b16 v[162:163], v18 offset:512
    ds_read_b128 v[148:151], v15 offset:2048
    v_mfma_f32_16x16x32_bf16 v[104:107], v[136:139], v[176:179], v[104:107]
    ds_read_b64_tr_b16 v[164:165], v19 offset:0
    ds_read_b64_tr_b16 v[166:167], v19 offset:512
    v_mfma_f32_16x16x32_bf16 v[108:111], v[140:143], v[176:179], v[108:111]
    ds_read_b128 v[152:155], v15 offset:4096
    ds_read_b64_tr_b16 v[168:169], v18 offset:4096
    v_mfma_f32_16x16x32_bf16 v[112:115], v[128:131], v[180:183], v[112:115]
    ds_read_b64_tr_b16 v[170:171], v18 offset:4608
    ds_read_b128 v[156:159], v15 offset:6144
    v_mfma_f32_16x16x32_bf16 v[116:119], v[132:135], v[180:183], v[116:119]
    s_mov_b32 s3, s34
    s_mov_b32 s34, s35
    v_mfma_f32_16x16x32_bf16 v[120:123], v[136:139], v[180:183], v[120:123]
    s_add_u32 s35, s35, 24576
    s_cmp_eq_u32 s35, 98304
    v_mfma_f32_16x16x32_bf16 v[124:127], v[140:143], v[180:183], v[124:127]
    s_cselect_b32 s35, 0, s35
    s_waitcnt lgkmcnt(0)
    v_mfma_f32_16x16x32_bf16 v[32:35], v[160:163], v[144:147], v[32:35]
    ds_read_b64_tr_b16 v[172:173], v19 offset:4096
    v_mfma_f32_16x16x32_bf16 v[36:39], v[160:163], v[148:151], v[36:39]
    v_mfma_f32_16x16x32_bf16 v[40:43], v[160:163], v[152:155], v[40:43]
    ds_read_b64_tr_b16 v[174:175], v19 offset:4608
    v_mfma_f32_16x16x32_bf16 v[44:47], v[160:163], v[156:159], v[44:47]
    v_mfma_f32_16x16x32_bf16 v[48:51], v[164:167], v[144:147], v[48:51]
    ds_read_b64_tr_b16 v[176:177], v18 offset:8192
    v_mfma_f32_16x16x32_bf16 v[52:55], v[164:167], v[148:151], v[52:55]
    v_mfma_f32_16x16x32_bf16 v[56:59], v[164:167], v[152:155], v[56:59]
    ds_read_b64_tr_b16 v[178:179], v18 offset:8704
    v_mfma_f32_16x16x32_bf16 v[60:63], v[164:167], v[156:159], v[60:63]
    v_mfma_f32_16x16x32_bf16 v[64:67], v[168:171], v[144:147], v[64:67]
    ds_read_b64_tr_b16 v[180:181], v19 offset:8192
    v_mfma_f32_16x16x32_bf16 v[68:71], v[168:171], v[148:151], v[68:71]
    v_mfma_f32_16x16x32_bf16 v[72:75], v[168:171], v[152:155], v[72:75]
    ds_read_b64_tr_b16 v[182:183], v19 offset:8704
    v_mfma_f32_16x16x32_bf16 v[76:79], v[168:171], v[156:159], v[76:79]
    s_waitcnt lgkmcnt(0)
    s_nop 0
    v_mfma_f32_16x16x32_bf16 v[80:83], v[172:175], v[144:147], v[80:83]
    v_add_u32_e64 v18, s35, v16
    v_mfma_f32_16x16x32_bf16 v[84:87], v[172:175], v[148:151], v[84:87]
    v_add_u32_e64 v19, s35, v17
    v_mfma_f32_16x16x32_bf16 v[88:91], v[172:175], v[152:155], v[88:91]
    v_add_u32_e64 v14, s37, v10
    v_mfma_f32_16x16x32_bf16 v[92:95], v[172:175], v[156:159], v[92:95]
    v_add_u32 v15, s37, v11
    s_barrier
    v_mfma_f32_16x16x32_bf16 v[96:99], v[144:147], v[176:179], v[96:99]
    ds_read_b128 v[128:131], v14 offset:0
    ds_read_b64_tr_b16 v[160:161], v18 offset:0
    ds_read_b64_tr_b16 v[162:163], v18 offset:512
    v_mfma_f32_16x16x32_bf16 v[100:103], v[148:151], v[176:179], v[100:103]
    ds_read_b128 v[132:135], v14 offset:2048
    ds_read_b64_tr_b16 v[164:165], v19 offset:0
    v_mfma_f32_16x16x32_bf16 v[104:107], v[152:155], v[176:179], v[104:107]
    ds_read_b64_tr_b16 v[166:167], v19 offset:512
    ds_read_b128 v[136:139], v14 offset:4096
    v_mfma_f32_16x16x32_bf16 v[108:111], v[156:159], v[176:179], v[108:111]
    ds_read_b64_tr_b16 v[168:169], v18 offset:4096
    ds_read_b64_tr_b16 v[170:171], v18 offset:4608
    v_mfma_f32_16x16x32_bf16 v[112:115], v[144:147], v[180:183], v[112:115]
    ds_read_b128 v[140:143], v14 offset:6144
    s_mov_b32 s3, s34
    s_mov_b32 s34, s35
    v_mfma_f32_16x16x32_bf16 v[116:119], v[148:151], v[180:183], v[116:119]
    s_add_u32 s35, s35, 24576
    s_cmp_eq_u32 s35, 98304
    v_mfma_f32_16x16x32_bf16 v[120:123], v[152:155], v[180:183], v[120:123]
    s_cselect_b32 s35, 0, s35
    s_nop 0
    s_add_u32 s37, s37, 16384
    v_mfma_f32_16x16x32_bf16 v[124:127], v[156:159], v[180:183], v[124:127]
    s_cmp_eq_u32 s37, 49152
    s_cselect_b32 s37, 0, s37
    s_waitcnt lgkmcnt(0)
    v_mfma_f32_16x16x32_bf16 v[32:35], v[160:163], v[128:131], v[32:35]
    ds_read_b64_tr_b16 v[172:173], v19 offset:4096
    v_mfma_f32_16x16x32_bf16 v[36:39], v[160:163], v[132:135], v[36:39]
    v_mfma_f32_16x16x32_bf16 v[40:43], v[160:163], v[136:139], v[40:43]
    ds_read_b64_tr_b16 v[174:175], v19 offset:4608
    v_mfma_f32_16x16x32_bf16 v[44:47], v[160:163], v[140:143], v[44:47]
    v_mfma_f32_16x16x32_bf16 v[48:51], v[164:167], v[128:131], v[48:51]
    ds_read_b64_tr_b16 v[176:177], v18 offset:8192
    v_mfma_f32_16x16x32_bf16 v[52:55], v[164:167], v[132:135], v[52:55]
    v_mfma_f32_16x16x32_bf16 v[56:59], v[164:167], v[136:139], v[56:59]
    ds_read_b64_tr_b16 v[178:179], v18 offset:8704
    v_mfma_f32_16x16x32_bf16 v[60:63], v[164:167], v[140:143], v[60:63]
    v_mfma_f32_16x16x32_bf16 v[64:67], v[168:171], v[128:131], v[64:67]
    ds_read_b64_tr_b16 v[180:181], v19 offset:8192
    v_mfma_f32_16x16x32_bf16 v[68:71], v[168:171], v[132:135], v[68:71]
    v_mfma_f32_16x16x32_bf16 v[72:75], v[168:171], v[136:139], v[72:75]
    ds_read_b64_tr_b16 v[182:183], v19 offset:8704
    v_mfma_f32_16x16x32_bf16 v[76:79], v[168:171], v[140:143], v[76:79]
    s_waitcnt lgkmcnt(0)
    s_nop 0
    v_mfma_f32_16x16x32_bf16 v[80:83], v[172:175], v[128:131], v[80:83]
    v_add_u32_e64 v18, s35, v16
    v_mfma_f32_16x16x32_bf16 v[84:87], v[172:175], v[132:135], v[84:87]
    v_mfma_f32_16x16x32_bf16 v[88:91], v[172:175], v[136:139], v[88:91]
    v_add_u32_e64 v19, s35, v17
    v_mfma_f32_16x16x32_bf16 v[92:95], v[172:175], v[140:143], v[92:95]
    s_barrier
    s_nop 0
    v_mfma_f32_16x16x32_bf16 v[96:99], v[128:131], v[176:179], v[96:99]
    ds_read_b128 v[144:147], v15 offset:0
    ds_read_b64_tr_b16 v[160:161], v18 offset:0
    v_mfma_f32_16x16x32_bf16 v[100:103], v[132:135], v[176:179], v[100:103]
    ds_read_b64_tr_b16 v[162:163], v18 offset:512
    ds_read_b128 v[148:151], v15 offset:2048
    v_mfma_f32_16x16x32_bf16 v[104:107], v[136:139], v[176:179], v[104:107]
    ds_read_b64_tr_b16 v[164:165], v19 offset:0
    ds_read_b64_tr_b16 v[166:167], v19 offset:512
    v_mfma_f32_16x16x32_bf16 v[108:111], v[140:143], v[176:179], v[108:111]
    ds_read_b128 v[152:155], v15 offset:4096
    ds_read_b64_tr_b16 v[168:169], v18 offset:4096
    v_mfma_f32_16x16x32_bf16 v[112:115], v[128:131], v[180:183], v[112:115]
    ds_read_b64_tr_b16 v[170:171], v18 offset:4608
    ds_read_b128 v[156:159], v15 offset:6144
    v_mfma_f32_16x16x32_bf16 v[116:119], v[132:135], v[180:183], v[116:119]
    s_mov_b32 s3, s34
    s_mov_b32 s34, s35
    v_mfma_f32_16x16x32_bf16 v[120:123], v[136:139], v[180:183], v[120:123]
    s_add_u32 s35, s35, 24576
    s_cmp_eq_u32 s35, 98304
    v_mfma_f32_16x16x32_bf16 v[124:127], v[140:143], v[180:183], v[124:127]
    s_cselect_b32 s35, 0, s35
    s_waitcnt lgkmcnt(0)
    v_mfma_f32_16x16x32_bf16 v[32:35], v[160:163], v[144:147], v[32:35]
    ds_read_b64_tr_b16 v[172:173], v19 offset:4096
    v_mfma_f32_16x16x32_bf16 v[36:39], v[160:163], v[148:151], v[36:39]
    v_mfma_f32_16x16x32_bf16 v[40:43], v[160:163], v[152:155], v[40:43]
    ds_read_b64_tr_b16 v[174:175], v19 offset:4608
    v_mfma_f32_16x16x32_bf16 v[44:47], v[160:163], v[156:159], v[44:47]
    v_mfma_f32_16x16x32_bf16 v[48:51], v[164:167], v[144:147], v[48:51]
    ds_read_b64_tr_b16 v[176:177], v18 offset:8192
    v_mfma_f32_16x16x32_bf16 v[52:55], v[164:167], v[148:151], v[52:55]
    v_mfma_f32_16x16x32_bf16 v[56:59], v[164:167], v[152:155], v[56:59]
    ds_read_b64_tr_b16 v[178:179], v18 offset:8704
    v_mfma_f32_16x16x32_bf16 v[60:63], v[164:167], v[156:159], v[60:63]
    v_mfma_f32_16x16x32_bf16 v[64:67], v[168:171], v[144:147], v[64:67]
    ds_read_b64_tr_b16 v[180:181], v19 offset:8192
    v_mfma_f32_16x16x32_bf16 v[68:71], v[168:171], v[148:151], v[68:71]
    v_mfma_f32_16x16x32_bf16 v[72:75], v[168:171], v[152:155], v[72:75]
    ds_read_b64_tr_b16 v[182:183], v19 offset:8704
    v_mfma_f32_16x16x32_bf16 v[76:79], v[168:171], v[156:159], v[76:79]
    s_waitcnt lgkmcnt(0)
    s_nop 0
    v_mfma_f32_16x16x32_bf16 v[80:83], v[172:175], v[144:147], v[80:83]
    v_mfma_f32_16x16x32_bf16 v[84:87], v[172:175], v[148:151], v[84:87]
    v_mfma_f32_16x16x32_bf16 v[88:91], v[172:175], v[152:155], v[88:91]
    v_mfma_f32_16x16x32_bf16 v[92:95], v[172:175], v[156:159], v[92:95]
    v_mfma_f32_16x16x32_bf16 v[96:99], v[144:147], v[176:179], v[96:99]
    v_mfma_f32_16x16x32_bf16 v[100:103], v[148:151], v[176:179], v[100:103]
    v_mfma_f32_16x16x32_bf16 v[104:107], v[152:155], v[176:179], v[104:107]
    v_mfma_f32_16x16x32_bf16 v[108:111], v[156:159], v[176:179], v[108:111]
    v_mfma_f32_16x16x32_bf16 v[112:115], v[144:147], v[180:183], v[112:115]
    v_mfma_f32_16x16x32_bf16 v[116:119], v[148:151], v[180:183], v[116:119]
    v_mfma_f32_16x16x32_bf16 v[120:123], v[152:155], v[180:183], v[120:123]
    v_mfma_f32_16x16x32_bf16 v[124:127], v[156:159], v[180:183], v[124:127]
    s_mov_b32 s53, 0
    s_waitcnt vmcnt(0)
L_nonce:
    v_readfirstlane_b32 s58, v25
    s_add_u32 s53, s53, 1
    s_cmp_lg_u32 s58, 0
    s_cbranch_scc1 L_nonce_ok
    v_mov_b32_e64 v20, 0
    buffer_load_dword v25, v20, s[16:19], 0 offen sc1
    s_waitcnt vmcnt(0)
    s_nop 0
    s_cmp_lt_u32 s53, 400000
    s_cbranch_scc1 L_nonce
L_nonce_ok:
    s_nop 0
    v_mov_b32 v20, 49152
    v_mov_b32_e64 v21, s58
    ds_write_b32 v20, v21
    v_lshlrev_b32_e64 v24, 4, v1
    s_and_b32 s54, s28, 3
    s_lshl_b32 s48, s54, 12
    s_add_u32 s48, s48, 53248
    v_add_u32_e64 v20, s48, v24
    s_mov_b32 s52, 0x3fb8aa3b
    s_mov_b32 s53, 0x3fb8aa3b
    v_pk_mul_f32 v[32:33], v[32:33], s[52:53]
    v_pk_mul_f32 v[34:35], v[34:35], s[52:53]
    v_pk_mul_f32 v[36:37], v[36:37], s[52:53]
    v_pk_mul_f32 v[38:39], v[38:39], s[52:53]
    v_pk_mul_f32 v[40:41], v[40:41], s[52:53]
    v_pk_mul_f32 v[42:43], v[42:43], s[52:53]
    v_pk_mul_f32 v[44:45], v[44:45], s[52:53]
    v_pk_mul_f32 v[46:47], v[46:47], s[52:53]
    v_pk_mul_f32 v[48:49], v[48:49], s[52:53]
    v_pk_mul_f32 v[50:51], v[50:51], s[52:53]
    v_pk_mul_f32 v[52:53], v[52:53], s[52:53]
    v_pk_mul_f32 v[54:55], v[54:55], s[52:53]
    v_pk_mul_f32 v[56:57], v[56:57], s[52:53]
    v_pk_mul_f32 v[58:59], v[58:59], s[52:53]
    v_pk_mul_f32 v[60:61], v[60:61], s[52:53]
    v_pk_mul_f32 v[62:63], v[62:63], s[52:53]
    v_cvt_pk_bf16_f32 v128, v32, v33
    v_cvt_pk_bf16_f32 v129, v34, v35
    v_cvt_pk_bf16_f32 v130, v36, v37
    v_cvt_pk_bf16_f32 v131, v38, v39
    v_cvt_pk_bf16_f32 v132, v48, v49
    v_cvt_pk_bf16_f32 v133, v50, v51
    v_cvt_pk_bf16_f32 v134, v52, v53
    v_cvt_pk_bf16_f32 v135, v54, v55
    v_cvt_pk_bf16_f32 v136, v40, v41
    v_cvt_pk_bf16_f32 v137, v42, v43
    v_cvt_pk_bf16_f32 v138, v44, v45
    v_cvt_pk_bf16_f32 v139, v46, v47
    v_cvt_pk_bf16_f32 v140, v56, v57
    v_cvt_pk_bf16_f32 v141, v58, v59
    v_cvt_pk_bf16_f32 v142, v60, v61
    v_cvt_pk_bf16_f32 v143, v62, v63
    v_permlane16_swap_b32 v128, v130
    v_permlane16_swap_b32 v129, v131
    v_permlane16_swap_b32 v132, v134
    v_permlane16_swap_b32 v133, v135
    v_permlane16_swap_b32 v136, v138
    v_permlane16_swap_b32 v137, v139
    v_permlane16_swap_b32 v140, v142
    v_permlane16_swap_b32 v141, v143
    ds_write_b128 v20, v[128:131] offset:0
    ds_write_b128 v20, v[132:135] offset:1024
    ds_write_b128 v20, v[136:139] offset:2048
    ds_write_b128 v20, v[140:143] offset:3072
    s_waitcnt lgkmcnt(0)
    s_barrier
    s_mov_b32 s52, 0x3fb8aa3b
    s_mov_b32 s53, 0x3fb8aa3b
    v_pk_mul_f32 v[64:65], v[64:65], s[52:53]
    v_pk_mul_f32 v[66:67], v[66:67], s[52:53]
    v_pk_mul_f32 v[68:69], v[68:69], s[52:53]
    v_pk_mul_f32 v[70:71], v[70:71], s[52:53]
    v_pk_mul_f32 v[72:73], v[72:73], s[52:53]
    v_pk_mul_f32 v[74:75], v[74:75], s[52:53]
    v_pk_mul_f32 v[76:77], v[76:77], s[52:53]
    v_pk_mul_f32 v[78:79], v[78:79], s[52:53]
    v_pk_mul_f32 v[80:81], v[80:81], s[52:53]
    v_pk_mul_f32 v[82:83], v[82:83], s[52:53]
    v_pk_mul_f32 v[84:85], v[84:85], s[52:53]
    v_pk_mul_f32 v[86:87], v[86:87], s[52:53]
    v_pk_mul_f32 v[88:89], v[88:89], s[52:53]
    v_pk_mul_f32 v[90:91], v[90:91], s[52:53]
    v_pk_mul_f32 v[92:93], v[92:93], s[52:53]
    v_pk_mul_f32 v[94:95], v[94:95], s[52:53]
    v_cvt_pk_bf16_f32 v132, v64, v65
    v_cvt_pk_bf16_f32 v133, v66, v67
    v_cvt_pk_bf16_f32 v134, v68, v69
    v_cvt_pk_bf16_f32 v135, v70, v71
    v_cvt_pk_bf16_f32 v136, v80, v81
    v_cvt_pk_bf16_f32 v137, v82, v83
    v_cvt_pk_bf16_f32 v138, v84, v85
    v_cvt_pk_bf16_f32 v139, v86, v87
    v_cvt_pk_bf16_f32 v140, v72, v73
    v_cvt_pk_bf16_f32 v141, v74, v75
    v_cvt_pk_bf16_f32 v142, v76, v77
    v_cvt_pk_bf16_f32 v143, v78, v79
    v_cvt_pk_bf16_f32 v144, v88, v89
    v_cvt_pk_bf16_f32 v145, v90, v91
    v_cvt_pk_bf16_f32 v146, v92, v93
    v_cvt_pk_bf16_f32 v147, v94, v95
    v_permlane16_swap_b32 v132, v134
    v_permlane16_swap_b32 v133, v135
    v_permlane16_swap_b32 v136, v138
    v_permlane16_swap_b32 v137, v139
    v_permlane16_swap_b32 v140, v142
    v_permlane16_swap_b32 v141, v143
    v_permlane16_swap_b32 v144, v146
    v_permlane16_swap_b32 v145, v147
    v_cvt_pk_bf16_f32 v148, v96, v97
    v_cvt_pk_bf16_f32 v149, v98, v99
    v_cvt_pk_bf16_f32 v150, v112, v113
    v_cvt_pk_bf16_f32 v151, v114, v115
    v_cvt_pk_bf16_f32 v152, v100, v101
    v_cvt_pk_bf16_f32 v153, v102, v103
    v_cvt_pk_bf16_f32 v154, v116, v117
    v_cvt_pk_bf16_f32 v155, v118, v119
    v_cvt_pk_bf16_f32 v156, v104, v105
    v_cvt_pk_bf16_f32 v157, v106, v107
    v_cvt_pk_bf16_f32 v158, v120, v121
    v_cvt_pk_bf16_f32 v159, v122, v123
    v_cvt_pk_bf16_f32 v160, v108, v109
    v_cvt_pk_bf16_f32 v161, v110, v111
    v_cvt_pk_bf16_f32 v162, v124, v125
    v_cvt_pk_bf16_f32 v163, v126, v127
    v_permlane16_swap_b32 v148, v150
    v_permlane16_swap_b32 v149, v151
    v_permlane16_swap_b32 v152, v154
    v_permlane16_swap_b32 v153, v155
    v_permlane16_swap_b32 v156, v158
    v_permlane16_swap_b32 v157, v159
    v_permlane16_swap_b32 v160, v162
    v_permlane16_swap_b32 v161, v163
    v_permlane32_swap_b32 v148, v150
    v_permlane32_swap_b32 v149, v151
    v_permlane32_swap_b32 v152, v154
    v_permlane32_swap_b32 v153, v155
    v_permlane32_swap_b32 v156, v158
    v_permlane32_swap_b32 v157, v159
    v_permlane32_swap_b32 v160, v162
    v_permlane32_swap_b32 v161, v163
    s_and_b32 s54, s28, 3
    s_cmp_lg_u32 s28, 4
    s_cbranch_scc1 L_nogflag
    s_add_u32 s48, s59, 64
    v_mov_b32 v20, 0
    v_mov_b32 v21, s58
    v_cmp_eq_u32 vcc, 0, v1
    s_and_saveexec_b64 s[50:51], vcc
    buffer_store_dword v21, v20, s[20:23], s48 offen sc1
    s_mov_b64 exec, s[50:51]
L_nogflag:
    s_nop 0
    v_mov_b32 v128, 0x3f803f80
    v_mov_b32 v129, 0x3f803f80
    v_mov_b32 v130, 0x3f803f80
    v_mov_b32 v131, 0x3f803f80
    v_mfma_f32_32x32x16_bf16 v[96:111], v[2:5], v[132:135], 0
    v_mfma_f32_32x32x16_bf16 v[96:111], v[6:9], v[136:139], v[96:111]
    s_nop 11
    s_nop 0
    v_max3_f32 v164, v96, v97, v98
    v_min3_f32 v166, v96, v97, v98
    v_max3_f32 v164, v164, v99, v100
    v_min3_f32 v166, v166, v99, v100
    v_max3_f32 v164, v164, v101, v102
    v_min3_f32 v166, v166, v101, v102
    v_max3_f32 v164, v164, v103, v104
    v_min3_f32 v166, v166, v103, v104
    v_max3_f32 v164, v164, v105, v106
    v_min3_f32 v166, v166, v105, v106
    v_max3_f32 v164, v164, v107, v108
    v_min3_f32 v166, v166, v107, v108
    v_max3_f32 v164, v164, v109, v110
    v_min3_f32 v166, v166, v109, v110
    v_max_f32 v164, v164, v111
    v_min_f32 v166, v166, v111
    v_mov_b32 v165, v164
    v_mov_b32 v167, v166
    s_nop 0
    v_permlane32_swap_b32 v164, v165
    v_permlane32_swap_b32 v166, v167
    v_max_f32 v164, v164, v165
    v_min_f32 v166, v166, v167
    v_mov_b32 v165, v164
    v_mov_b32_e64 v167, v166
    v_pk_add_f32 v[112:113], v[96:97], v[164:165] neg_lo:[0,1] neg_hi:[0,1]
    v_pk_add_f32 v[114:115], v[98:99], v[164:165] neg_lo:[0,1] neg_hi:[0,1]
    v_pk_add_f32 v[116:117], v[100:101], v[164:165] neg_lo:[0,1] neg_hi:[0,1]
    v_pk_add_f32 v[118:119], v[102:103], v[164:165] neg_lo:[0,1] neg_hi:[0,1]
    v_pk_add_f32 v[120:121], v[104:105], v[164:165] neg_lo:[0,1] neg_hi:[0,1]
    v_pk_add_f32 v[122:123], v[106:107], v[164:165] neg_lo:[0,1] neg_hi:[0,1]
    v_pk_add_f32 v[124:125], v[108:109], v[164:165] neg_lo:[0,1] neg_hi:[0,1]
    v_pk_add_f32 v[126:127], v[110:111], v[164:165] neg_lo:[0,1] neg_hi:[0,1]
    v_pk_add_f32 v[96:97], v[166:167], v[96:97] neg_lo:[0,1] neg_hi:[0,1]
    v_pk_add_f32 v[98:99], v[166:167], v[98:99] neg_lo:[0,1] neg_hi:[0,1]
    v_pk_add_f32 v[100:101], v[166:167], v[100:101] neg_lo:[0,1] neg_hi:[0,1]
    v_pk_add_f32 v[102:103], v[166:167], v[102:103] neg_lo:[0,1] neg_hi:[0,1]
    v_pk_add_f32 v[104:105], v[166:167], v[104:105] neg_lo:[0,1] neg_hi:[0,1]
    v_pk_add_f32 v[106:107], v[166:167], v[106:107] neg_lo:[0,1] neg_hi:[0,1]
    v_pk_add_f32 v[108:109], v[166:167], v[108:109] neg_lo:[0,1] neg_hi:[0,1]
    v_pk_add_f32 v[110:111], v[166:167], v[110:111] neg_lo:[0,1] neg_hi:[0,1]
    v_exp_f32 v112, v112
    v_exp_f32 v113, v113
    v_exp_f32 v114, v114
    v_exp_f32 v115, v115
    v_exp_f32 v116, v116
    v_exp_f32 v117, v117
    v_exp_f32 v118, v118
    v_exp_f32 v119, v119
    v_exp_f32 v120, v120
    v_exp_f32 v121, v121
    v_exp_f32 v122, v122
    v_exp_f32 v123, v123
    v_exp_f32 v124, v124
    v_exp_f32 v125, v125
    v_exp_f32 v126, v126
    v_exp_f32 v127, v127
    v_exp_f32 v96, v96
    v_exp_f32 v97, v97
    v_exp_f32 v98, v98
    v_exp_f32 v99, v99
    v_exp_f32 v100, v100
    v_exp_f32 v101, v101
    v_exp_f32 v102, v102
    v_exp_f32 v103, v103
    v_exp_f32 v104, v104
    v_exp_f32 v105, v105
    v_exp_f32 v106, v106
    v_exp_f32 v107, v107
    v_exp_f32 v108, v108
    v_exp_f32 v109, v109
    v_exp_f32 v110, v110
    v_exp_f32 v111, v111
    v_pk_add_f32 v[168:169], v[112:113], v[114:115]
    v_pk_add_f32 v[172:173], v[116:117], v[118:119]
    v_pk_add_f32 v[168:169], v[168:169], v[120:121]
    v_pk_add_f32 v[172:173], v[172:173], v[122:123]
    v_pk_add_f32 v[168:169], v[168:169], v[124:125]
    v_pk_add_f32 v[172:173], v[172:173], v[126:127]
    v_pk_add_f32 v[168:169], v[168:169], v[172:173]
    v_add_f32 v168, v168, v169
    v_mov_b32 v169, v168
    v_pk_add_f32 v[170:171], v[96:97], v[98:99]
    v_pk_add_f32 v[174:175], v[100:101], v[102:103]
    v_pk_add_f32 v[170:171], v[170:171], v[104:105]
    v_pk_add_f32 v[174:175], v[174:175], v[106:107]
    v_pk_add_f32 v[170:171], v[170:171], v[108:109]
    v_pk_add_f32 v[174:175], v[174:175], v[110:111]
    v_pk_add_f32 v[170:171], v[170:171], v[174:175]
    v_add_f32 v170, v170, v171
    v_mov_b32 v171, v170
    v_permlane32_swap_b32 v168, v169
    s_nop 0
    v_permlane32_swap_b32 v170, v171
    v_add_f32 v168, v168, v169
    v_add_f32 v170, v170, v171
    v_rcp_f32 v168, v168
    v_rcp_f32 v170, v170
    v_mov_b32 v169, v168
    v_mov_b32_e64 v171, v170
    v_pk_mul_f32 v[112:113], v[112:113], v[168:169]
    v_pk_mul_f32 v[96:97], v[96:97], v[170:171]
    v_pk_mul_f32 v[114:115], v[114:115], v[168:169]
    v_pk_mul_f32 v[98:99], v[98:99], v[170:171]
    v_pk_mul_f32 v[116:117], v[116:117], v[168:169]
    v_pk_mul_f32 v[100:101], v[100:101], v[170:171]
    v_pk_mul_f32 v[118:119], v[118:119], v[168:169]
    v_pk_mul_f32 v[102:103], v[102:103], v[170:171]
    v_pk_mul_f32 v[120:121], v[120:121], v[168:169]
    v_pk_mul_f32 v[104:105], v[104:105], v[170:171]
    v_pk_mul_f32 v[122:123], v[122:123], v[168:169]
    v_pk_mul_f32 v[106:107], v[106:107], v[170:171]
    v_pk_mul_f32 v[124:125], v[124:125], v[168:169]
    v_pk_mul_f32 v[108:109], v[108:109], v[170:171]
    v_pk_mul_f32 v[126:127], v[126:127], v[168:169]
    v_pk_mul_f32 v[110:111], v[110:111], v[170:171]
    v_cvt_pk_bf16_f32 v176, v112, v113
    v_cvt_pk_bf16_f32 v177, v114, v115
    v_cvt_pk_bf16_f32 v178, v116, v117
    v_cvt_pk_bf16_f32 v179, v118, v119
    v_cvt_pk_bf16_f32 v180, v120, v121
    v_cvt_pk_bf16_f32 v181, v122, v123
    v_cvt_pk_bf16_f32 v182, v124, v125
    v_cvt_pk_bf16_f32 v183, v126, v127
    v_cvt_pk_bf16_f32 v184, v96, v97
    v_cvt_pk_bf16_f32 v185, v98, v99
    v_cvt_pk_bf16_f32 v186, v100, v101
    v_cvt_pk_bf16_f32 v187, v102, v103
    v_cvt_pk_bf16_f32 v188, v104, v105
    v_cvt_pk_bf16_f32 v189, v106, v107
    v_cvt_pk_bf16_f32 v190, v108, v109
    v_cvt_pk_bf16_f32 v191, v110, v111
    v_mfma_f32_32x32x16_bf16 v[96:111], v[176:179], v[216:219], 0
    v_mfma_f32_32x32x16_bf16 v[96:111], v[180:183], v[220:223], v[96:111]
    v_mfma_f32_32x32x16_bf16 v[112:127], v[184:187], v[216:219], 0
    v_mfma_f32_32x32x16_bf16 v[112:127], v[188:191], v[220:223], v[112:127]
    s_nop 9
    s_nop 0
    v_cvt_pk_bf16_f32 v176, v96, v97
    v_cvt_pk_bf16_f32 v177, v98, v99
    v_cvt_pk_bf16_f32 v178, v100, v101
    v_cvt_pk_bf16_f32 v179, v102, v103
    v_cvt_pk_bf16_f32 v180, v104, v105
    v_cvt_pk_bf16_f32 v181, v106, v107
    v_cvt_pk_bf16_f32 v182, v108, v109
    v_cvt_pk_bf16_f32 v183, v110, v111
    v_cvt_pk_bf16_f32 v184, v112, v113
    v_cvt_pk_bf16_f32 v185, v114, v115
    v_cvt_pk_bf16_f32 v186, v116, v117
    v_cvt_pk_bf16_f32 v187, v118, v119
    v_cvt_pk_bf16_f32 v188, v120, v121
    v_cvt_pk_bf16_f32 v189, v122, v123
    v_cvt_pk_bf16_f32 v190, v124, v125
    v_cvt_pk_bf16_f32 v191, v126, v127
    v_mfma_f32_32x32x16_bf16 v[32:47], v[176:179], v[148:151], 0
    v_mfma_f32_32x32x16_bf16 v[224:239], v[176:179], v[128:131], 0
    v_mfma_f32_32x32x16_bf16 v[32:47], v[180:183], v[152:155], v[32:47]
    v_mfma_f32_32x32x16_bf16 v[224:239], v[180:183], v[128:131], v[224:239]
    v_mfma_f32_32x32x16_bf16 v[48:63], v[184:187], v[148:151], 0
    v_mfma_f32_32x32x16_bf16 v[240:255], v[184:187], v[128:131], 0
    v_mfma_f32_32x32x16_bf16 v[48:63], v[188:191], v[152:155], v[48:63]
    v_mfma_f32_32x32x16_bf16 v[240:255], v[188:191], v[128:131], v[240:255]
    v_mfma_f32_32x32x16_bf16 v[96:111], v[2:5], v[140:143], 0
    v_mfma_f32_32x32x16_bf16 v[96:111], v[6:9], v[144:147], v[96:111]
    s_nop 11
    s_nop 0
    v_max3_f32 v164, v96, v97, v98
    v_min3_f32 v166, v96, v97, v98
    v_max3_f32 v164, v164, v99, v100
    v_min3_f32 v166, v166, v99, v100
    v_max3_f32 v164, v164, v101, v102
    v_min3_f32 v166, v166, v101, v102
    v_max3_f32 v164, v164, v103, v104
    v_min3_f32 v166, v166, v103, v104
    v_max3_f32 v164, v164, v105, v106
    v_min3_f32 v166, v166, v105, v106
    v_max3_f32 v164, v164, v107, v108
    v_min3_f32 v166, v166, v107, v108
    v_max3_f32 v164, v164, v109, v110
    v_min3_f32 v166, v166, v109, v110
    v_max_f32 v164, v164, v111
    v_min_f32 v166, v166, v111
    v_mov_b32 v165, v164
    v_mov_b32 v167, v166
    s_nop 0
    v_permlane32_swap_b32 v164, v165
    v_permlane32_swap_b32 v166, v167
    v_max_f32 v164, v164, v165
    v_min_f32 v166, v166, v167
    v_mov_b32 v165, v164
    v_mov_b32_e64 v167, v166
    v_pk_add_f32 v[112:113], v[96:97], v[164:165] neg_lo:[0,1] neg_hi:[0,1]
    v_pk_add_f32 v[114:115], v[98:99], v[164:165] neg_lo:[0,1] neg_hi:[0,1]
    v_pk_add_f32 v[116:117], v[100:101], v[164:165] neg_lo:[0,1] neg_hi:[0,1]
    v_pk_add_f32 v[118:119], v[102:103], v[164:165] neg_lo:[0,1] neg_hi:[0,1]
    v_pk_add_f32 v[120:121], v[104:105], v[164:165] neg_lo:[0,1] neg_hi:[0,1]
    v_pk_add_f32 v[122:123], v[106:107], v[164:165] neg_lo:[0,1] neg_hi:[0,1]
    v_pk_add_f32 v[124:125], v[108:109], v[164:165] neg_lo:[0,1] neg_hi:[0,1]
    v_pk_add_f32 v[126:127], v[110:111], v[164:165] neg_lo:[0,1] neg_hi:[0,1]
    v_pk_add_f32 v[96:97], v[166:167], v[96:97] neg_lo:[0,1] neg_hi:[0,1]
    v_pk_add_f32 v[98:99], v[166:167], v[98:99] neg_lo:[0,1] neg_hi:[0,1]
    v_pk_add_f32 v[100:101], v[166:167], v[100:101] neg_lo:[0,1] neg_hi:[0,1]
    v_pk_add_f32 v[102:103], v[166:167], v[102:103] neg_lo:[0,1] neg_hi:[0,1]
    v_pk_add_f32 v[104:105], v[166:167], v[104:105] neg_lo:[0,1] neg_hi:[0,1]
    v_pk_add_f32 v[106:107], v[166:167], v[106:107] neg_lo:[0,1] neg_hi:[0,1]
    v_pk_add_f32 v[108:109], v[166:167], v[108:109] neg_lo:[0,1] neg_hi:[0,1]
    v_pk_add_f32 v[110:111], v[166:167], v[110:111] neg_lo:[0,1] neg_hi:[0,1]
    v_exp_f32 v112, v112
    v_exp_f32 v113, v113
    v_exp_f32 v114, v114
    v_exp_f32 v115, v115
    v_exp_f32 v116, v116
    v_exp_f32 v117, v117
    v_exp_f32 v118, v118
    v_exp_f32 v119, v119
    v_exp_f32 v120, v120
    v_exp_f32 v121, v121
    v_exp_f32 v122, v122
    v_exp_f32 v123, v123
    v_exp_f32 v124, v124
    v_exp_f32 v125, v125
    v_exp_f32 v126, v126
    v_exp_f32 v127, v127
    v_exp_f32 v96, v96
    v_exp_f32 v97, v97
    v_exp_f32 v98, v98
    v_exp_f32 v99, v99
    v_exp_f32 v100, v100
    v_exp_f32 v101, v101
    v_exp_f32 v102, v102
    v_exp_f32 v103, v103
    v_exp_f32 v104, v104
    v_exp_f32 v105, v105
    v_exp_f32 v106, v106
    v_exp_f32 v107, v107
    v_exp_f32 v108, v108
    v_exp_f32 v109, v109
    v_exp_f32 v110, v110
    v_exp_f32 v111, v111
    v_pk_add_f32 v[168:169], v[112:113], v[114:115]
    v_pk_add_f32 v[172:173], v[116:117], v[118:119]
    v_pk_add_f32 v[168:169], v[168:169], v[120:121]
    v_pk_add_f32 v[172:173], v[172:173], v[122:123]
    v_pk_add_f32 v[168:169], v[168:169], v[124:125]
    v_pk_add_f32 v[172:173], v[172:173], v[126:127]
    v_pk_add_f32 v[168:169], v[168:169], v[172:173]
    v_add_f32 v168, v168, v169
    v_mov_b32 v169, v168
    v_pk_add_f32 v[170:171], v[96:97], v[98:99]
    v_pk_add_f32 v[174:175], v[100:101], v[102:103]
    v_pk_add_f32 v[170:171], v[170:171], v[104:105]
    v_pk_add_f32 v[174:175], v[174:175], v[106:107]
    v_pk_add_f32 v[170:171], v[170:171], v[108:109]
    v_pk_add_f32 v[174:175], v[174:175], v[110:111]
    v_pk_add_f32 v[170:171], v[170:171], v[174:175]
    v_add_f32 v170, v170, v171
    v_mov_b32 v171, v170
    v_permlane32_swap_b32 v168, v169
    s_nop 0
    v_permlane32_swap_b32 v170, v171
    v_add_f32 v168, v168, v169
    v_add_f32 v170, v170, v171
    v_rcp_f32 v168, v168
    v_rcp_f32 v170, v170
    v_mov_b32 v169, v168
    v_mov_b32_e64 v171, v170
    v_pk_mul_f32 v[112:113], v[112:113], v[168:169]
    v_pk_mul_f32 v[96:97], v[96:97], v[170:171]
    v_pk_mul_f32 v[114:115], v[114:115], v[168:169]
    v_pk_mul_f32 v[98:99], v[98:99], v[170:171]
    v_pk_mul_f32 v[116:117], v[116:117], v[168:169]
    v_pk_mul_f32 v[100:101], v[100:101], v[170:171]
    v_pk_mul_f32 v[118:119], v[118:119], v[168:169]
    v_pk_mul_f32 v[102:103], v[102:103], v[170:171]
    v_pk_mul_f32 v[120:121], v[120:121], v[168:169]
    v_pk_mul_f32 v[104:105], v[104:105], v[170:171]
    v_pk_mul_f32 v[122:123], v[122:123], v[168:169]
    v_pk_mul_f32 v[106:107], v[106:107], v[170:171]
    v_pk_mul_f32 v[124:125], v[124:125], v[168:169]
    v_pk_mul_f32 v[108:109], v[108:109], v[170:171]
    v_pk_mul_f32 v[126:127], v[126:127], v[168:169]
    v_pk_mul_f32 v[110:111], v[110:111], v[170:171]
    v_cvt_pk_bf16_f32 v176, v112, v113
    v_cvt_pk_bf16_f32 v177, v114, v115
    v_cvt_pk_bf16_f32 v178, v116, v117
    v_cvt_pk_bf16_f32 v179, v118, v119
    v_cvt_pk_bf16_f32 v180, v120, v121
    v_cvt_pk_bf16_f32 v181, v122, v123
    v_cvt_pk_bf16_f32 v182, v124, v125
    v_cvt_pk_bf16_f32 v183, v126, v127
    v_cvt_pk_bf16_f32 v184, v96, v97
    v_cvt_pk_bf16_f32 v185, v98, v99
    v_cvt_pk_bf16_f32 v186, v100, v101
    v_cvt_pk_bf16_f32 v187, v102, v103
    v_cvt_pk_bf16_f32 v188, v104, v105
    v_cvt_pk_bf16_f32 v189, v106, v107
    v_cvt_pk_bf16_f32 v190, v108, v109
    v_cvt_pk_bf16_f32 v191, v110, v111
    v_mfma_f32_32x32x16_bf16 v[96:111], v[176:179], v[216:219], 0
    v_mfma_f32_32x32x16_bf16 v[96:111], v[180:183], v[220:223], v[96:111]
    v_mfma_f32_32x32x16_bf16 v[112:127], v[184:187], v[216:219], 0
    v_mfma_f32_32x32x16_bf16 v[112:127], v[188:191], v[220:223], v[112:127]
    s_nop 9
    s_nop 0
    v_cvt_pk_bf16_f32 v176, v96, v97
    v_cvt_pk_bf16_f32 v177, v98, v99
    v_cvt_pk_bf16_f32 v178, v100, v101
    v_cvt_pk_bf16_f32 v179, v102, v103
    v_cvt_pk_bf16_f32 v180, v104, v105
    v_cvt_pk_bf16_f32 v181, v106, v107
    v_cvt_pk_bf16_f32 v182, v108, v109
    v_cvt_pk_bf16_f32 v183, v110, v111
    v_cvt_pk_bf16_f32 v184, v112, v113
    v_cvt_pk_bf16_f32 v185, v114, v115
    v_cvt_pk_bf16_f32 v186, v116, v117
    v_cvt_pk_bf16_f32 v187, v118, v119
    v_cvt_pk_bf16_f32 v188, v120, v121
    v_cvt_pk_bf16_f32 v189, v122, v123
    v_cvt_pk_bf16_f32 v190, v124, v125
    v_cvt_pk_bf16_f32 v191, v126, v127
    v_mfma_f32_32x32x16_bf16 v[32:47], v[176:179], v[156:159], v[32:47]
    v_mfma_f32_32x32x16_bf16 v[224:239], v[176:179], v[128:131], v[224:239]
    v_mfma_f32_32x32x16_bf16 v[32:47], v[180:183], v[160:163], v[32:47]
    v_mfma_f32_32x32x16_bf16 v[224:239], v[180:183], v[128:131], v[224:239]
    v_mfma_f32_32x32x16_bf16 v[48:63], v[184:187], v[156:159], v[48:63]
    v_mfma_f32_32x32x16_bf16 v[240:255], v[184:187], v[128:131], v[240:255]
    v_mfma_f32_32x32x16_bf16 v[48:63], v[188:191], v[160:163], v[48:63]
    v_mfma_f32_32x32x16_bf16 v[240:255], v[188:191], v[128:131], v[240:255]
    s_xor_b32 s48, s54, 1
    s_lshl_b32 s48, s48, 12
    s_add_u32 s48, s48, 98304
    v_add_u32 v20, s48, v24
    s_lshl_b32 s48, s54, 8
    s_add_u32 s48, s48, 155648
    v_lshrrev_b32 v21, 5, v1
    v_lshlrev_b32 v21, 6, v21
    v_add_u32 v21, s48, v21
    v_and_b32 v22, 31, v1
    v_cmp_eq_u32 vcc, 0, v22
    s_and_saveexec_b64 s[50:51], vcc
    ds_write_b128 v21, v[224:227] offset:0
    ds_write_b128 v21, v[228:231] offset:16
    ds_write_b128 v21, v[232:235] offset:32
    ds_write_b128 v21, v[236:239] offset:48
    ds_write_b128 v21, v[240:243] offset:128
    ds_write_b128 v21, v[244:247] offset:144
    ds_write_b128 v21, v[248:251] offset:160
    ds_write_b128 v21, v[252:255] offset:176
    s_mov_b64 exec, s[50:51]
    s_cmp_eq_u32 s33, 0
    s_cbranch_scc1 L_tg0
    s_nop 0
    ds_write_b128 v20, v[32:35] offset:0
    ds_write_b128 v20, v[36:39] offset:1024
    ds_write_b128 v20, v[40:43] offset:2048
    ds_write_b128 v20, v[44:47] offset:3072
    v_mov_b32 v32, v48
    v_mov_b32 v33, v49
    v_mov_b32 v34, v50
    v_mov_b32 v35, v51
    v_mov_b32 v36, v52
    v_mov_b32 v37, v53
    v_mov_b32 v38, v54
    v_mov_b32 v39, v55
    v_mov_b32 v40, v56
    v_mov_b32 v41, v57
    v_mov_b32 v42, v58
    v_mov_b32 v43, v59
    v_mov_b32 v44, v60
    v_mov_b32 v45, v61
    v_mov_b32 v46, v62
    v_mov_b32_e64 v47, v63
    s_branch L_tgj
L_tg0:
    ds_write_b128 v20, v[48:51] offset:0
    ds_write_b128 v20, v[52:55] offset:1024
    ds_write_b128 v20, v[56:59] offset:2048
    ds_write_b128 v20, v[60:63] offset:3072
L_tgj:
    s_waitcnt lgkmcnt(0)
    s_barrier
    s_lshl_b32 s48, s54, 12
    s_nop 0
    s_add_u32 s48, s48, 98304
    v_add_u32_e64 v20, s48, v24
    ds_read_b128 v[96:99], v20 offset:0
    ds_read_b128 v[100:103], v20 offset:1024
    ds_read_b128 v[104:107], v20 offset:2048
    ds_read_b128 v[108:111], v20 offset:3072
    s_lshl_b32 s48, s32, 9
    s_lshl_b32 s49, s33, 7
    s_add_u32 s48, s48, s49
    s_nop 0
    s_add_u32 s48, s48, 155648
    v_and_b32 v20, 7, v1
    v_lshlrev_b32 v20, 4, v20
    v_add_u32_e64 v21, s48, v20
    ds_read_b128 v[176:179], v21
    ds_read_b128 v[180:183], v21 offset:256
    s_lshl_b32 s48, s29, 1
    s_add_u32 s48, s48, s32
    s_lshl_b32 s55, s48, 4
    s_add_u32 s55, s55, s30
    s_lshl_b32 s48, s55, 13
    s_lshl_b32 s49, s33, 12
    s_add_u32 s48, s48, s49
    s_nop 0
    s_add_u32 s48, s48, 20971520
    s_waitcnt lgkmcnt(2)
    s_nop 0
    v_pk_add_f32 v[32:33], v[32:33], v[96:97]
    v_pk_add_f32 v[34:35], v[34:35], v[98:99]
    v_pk_add_f32 v[36:37], v[36:37], v[100:101]
    v_pk_add_f32 v[38:39], v[38:39], v[102:103]
    v_pk_add_f32 v[40:41], v[40:41], v[104:105]
    v_pk_add_f32 v[42:43], v[42:43], v[106:107]
    v_pk_add_f32 v[44:45], v[44:45], v[108:109]
    v_pk_add_f32 v[46:47], v[46:47], v[110:111]
    buffer_store_dwordx4 v[32:35], v24, s[20:23], s48 offen offset:0 sc1
    buffer_store_dwordx4 v[36:39], v24, s[20:23], s48 offen offset:1024 sc1
    buffer_store_dwordx4 v[40:43], v24, s[20:23], s48 offen offset:2048 sc1
    buffer_store_dwordx4 v[44:47], v24, s[20:23], s48 offen offset:3072 sc1
    s_waitcnt lgkmcnt(0)
    s_nop 0
    v_pk_add_f32 v[176:177], v[176:177], v[180:181]
    v_pk_add_f32 v[178:179], v[178:179], v[182:183]
    s_lshl_b32 s48, s55, 8
    s_lshl_b32 s49, s33, 7
    s_add_u32 s48, s48, s49
    s_nop 0
    s_add_u32 s48, s48, 25165824
    v_cmp_gt_u32 vcc, 8, v1
    s_and_saveexec_b64 s[50:51], vcc
    buffer_store_dwordx4 v[176:179], v20, s[20:23], s48 offen sc1
    s_mov_b64 exec, s[50:51]
L_Bx:
    s_and_b32 s54, s28, 3
    s_lshl_b32 s48, s54, 12
    s_nop 0
    s_add_u32 s48, s48, 114688
    v_add_u32_e64 v20, s48, v24
    ds_read_b128 v[4:7], v20 offset:2048
    ds_read_b128 v[8:11], v20 offset:3072
    ds_read_b128 v[12:15], v20
    ds_read_b128 v[16:19], v20 offset:1024
    s_lshl_b32 s48, s54, 12
    s_nop 0
    s_add_u32 s48, s48, 131072
    v_add_u32_e64 v20, s48, v24
    ds_read_b128 v[132:135], v20 offset:0
    ds_read_b128 v[136:139], v20 offset:1024
    ds_read_b128 v[140:143], v20 offset:2048
    ds_read_b128 v[144:147], v20 offset:3072
L_trans:
    s_waitcnt lgkmcnt(0)
    v_lshlrev_b32 v2, 4, v1
    s_lshl_b32 s34, s29, 1
    s_add_u32 s34, s34, s32
    s_lshl_b32 s47, s33, 1
    s_add_u32 s47, s47, s31
    s_lshl_b32 s46, s30, 2
    s_add_u32 s46, s46, s47
    v_mov_b32 v220, v2
    v_mov_b32_e64 v221, v2
    s_cmp_ge_u32 s28, 4
    s_cbranch_scc1 L_p2_common
    s_lshl_b32 s38, s28, 11
    s_lshl_b32 s48, s29, 19
    s_add_u32 s48, s48, s38
    s_add_u32 s48, s48, 4194304
    s_add_u32 s24, s42, s48
    s_addc_u32 s25, s43, 0
    s_mov_b32 s26, 0x40000
    s_mov_b32 s27, 0x20000
    s_add_u32 s4, s24, 0x40000
    s_addc_u32 s5, s25, 0
    s_nop 0
    s_mov_b32 s6, 0x40000
    s_mov_b32 s7, 0x20000
    s_mov_b32 s36, 8192
    s_mov_b32 s37, 0x3ffff
    v_mov_b32 v220, v2
    v_mov_b32_e64 v221, v2
    s_add_u32 s72, s38, 0
    s_add_u32 s73, s38, 16384
    s_add_u32 s74, s38, 32768
    s_add_u32 s75, s38, 49152
    s_add_u32 s76, s38, 65536
    s_add_u32 s77, s38, 81920
    s_add_u32 s78, s38, 98304
    s_add_u32 s79, s38, 114688
    s_lshl_b32 s39, s30, 14
    s_nop 0
    s_add_u32 s39, s39, 49152
    s_and_b32 s39, s39, 0x3ffff
L_p2_common:
    v_bfe_u32 v192, v1, 4, 1
    v_bfe_u32 v193, v1, 2, 1
    v_cmp_eq_u32 vcc, v192, v193
    s_nop 0
    v_mov_b32 v194, 0x3f803f80
    s_nop 0
    v_cndmask_b32 v188, 0, v194, vcc
    v_mov_b32 v189, v188
    v_mov_b32 v190, v188
    v_mov_b32 v191, v188
    s_lshl_b32 s48, s32, 13
    v_add_u32 v195, s48, v2
    s_lshl_b32 s49, s31, 12
    v_add_u32_e64 v196, s49, v195
    v_add_u32 v197, 65536, v196
    ds_read_b128 v[164:167], v195
    ds_read_b128 v[168:171], v195 offset:1024
    ds_read_b128 v[156:159], v196
    ds_read_b128 v[160:163], v196 offset:1024
    s_waitcnt lgkmcnt(2)
    s_nop 0
    v_mfma_f32_32x32x16_bf16 v[52:67], v[164:167], v[4:7], 0
    v_mfma_f32_32x32x16_bf16 v[52:67], v[168:171], v[8:11], v[52:67]
    v_mfma_f32_32x32x16_bf16 v[68:83], v[164:167], v[12:15], 0
    v_mfma_f32_32x32x16_bf16 v[68:83], v[168:171], v[16:19], v[68:83]
    v_mov_b64 v[100:101], 0
    v_mov_b64 v[102:103], 0
    v_mov_b64 v[104:105], 0
    v_mov_b64 v[106:107], 0
    v_mov_b64 v[108:109], 0
    v_mov_b64 v[110:111], 0
    v_mov_b64 v[112:113], 0
    v_mov_b64 v[114:115], 0
    v_mov_b64 v[148:149], 0
    v_mov_b64 v[150:151], 0
    v_mov_b64 v[116:117], 0
    v_mov_b64 v[118:119], 0
    v_mov_b64 v[120:121], 0
    v_mov_b64 v[122:123], 0
    v_mov_b64 v[124:125], 0
    v_mov_b64 v[126:127], 0
    v_mov_b64 v[128:129], 0
    v_mov_b64 v[130:131], 0
    v_mov_b64 v[152:153], 0
    v_mov_b64 v[154:155], 0
    v_mov_b64 v[92:93], 0
    v_mov_b64 v[180:181], 0
    v_mov_b64 v[94:95], 0
    v_mov_b64 v[182:183], 0
    v_mov_b64 v[96:97], 0
    v_mov_b64 v[184:185], 0
    v_mov_b64 v[98:99], 0
    v_mov_b64 v[186:187], 0
    v_max3_f32 v192, v52, v53, v54
    v_max3_f32 v192, v192, v55, v56
    v_max3_f32 v192, v192, v57, v58
    v_max3_f32 v192, v192, v59, v60
    v_max3_f32 v192, v192, v61, v62
    v_max3_f32 v192, v192, v63, v64
    v_max3_f32 v192, v192, v65, v66
    v_max_f32 v192, v192, v67
    v_mov_b32 v193, v192
    v_max3_f32 v194, v68, v69, v70
    v_max3_f32 v194, v194, v71, v72
    v_max3_f32 v194, v194, v73, v74
    v_max3_f32 v194, v194, v75, v76
    v_max3_f32 v194, v194, v77, v78
    v_max3_f32 v194, v194, v79, v80
    v_max3_f32 v194, v194, v81, v82
    v_max_f32 v194, v194, v83
    v_mov_b32 v195, v194
    v_permlane32_swap_b32 v192, v193
    s_nop 0
    v_permlane32_swap_b32 v194, v195
    v_max_f32 v192, v192, v193
    v_add_f32 v192, 0x42b40000, v192
    v_sub_f32 v20, 0, v192
    v_sub_f32 v21, 0, v192
    v_mov_b64 v[22:23], v[20:21]
    v_mov_b64 v[24:25], v[20:21]
    v_mov_b64 v[26:27], v[20:21]
    v_mov_b64 v[28:29], v[20:21]
    v_mov_b64 v[30:31], v[20:21]
    v_mov_b64 v[32:33], v[20:21]
    v_mov_b64 v[34:35], v[20:21]
    v_max_f32 v194, v194, v195
    v_add_f32 v194, 0x42b40000, v194
    v_sub_f32 v36, 0, v194
    v_sub_f32 v37, 0, v194
    v_mov_b64 v[38:39], v[36:37]
    v_mov_b64 v[40:41], v[36:37]
    v_mov_b64 v[42:43], v[36:37]
    v_mov_b64 v[44:45], v[36:37]
    v_mov_b64 v[46:47], v[36:37]
    v_mov_b64 v[48:49], v[36:37]
    v_mov_b64 v[50:51], v[36:37]
    s_waitcnt lgkmcnt(0)
    v_mfma_f32_32x32x16_bf16 v[52:67], v[156:159], v[4:7], v[20:35]
    v_mfma_f32_32x32x16_bf16 v[52:67], v[160:163], v[8:11], v[52:67]
    s_mov_b32 s35, 0
    s_nop 7
    s_mov_b32 s44, 0xba82501
    s_cmp_eq_u32 s28, 0
    s_nop 0
    s_cselect_b32 s44, 0x4baa6501, s44
    s_cmp_eq_u32 s28, 1
    s_nop 0
    s_cselect_b32 s44, 0xba92501, s44
    s_cmp_ge_u32 s28, 4
    s_nop 0
    s_cselect_b32 s44, 0x9000020, s44
    s_cmp_ge_u32 s28, 4
    s_cbranch_scc1 L_mainF
    s_setprio 1
L_mainL:
    s_waitcnt vmcnt(20)
    s_barrier
    s_nop 0
    v_mfma_f32_32x32x16_bf16 v[68:83], v[156:159], v[12:15], v[36:51]
    ds_read_b128 v[172:175], v196 offset:2048
    v_exp_f32 v52, v52
    v_exp_f32 v53, v53
    v_exp_f32 v54, v54
    v_exp_f32 v55, v55
    v_mfma_f32_32x32x16_bf16 v[68:83], v[160:163], v[16:19], v[68:83]
    ds_read_b128 v[176:179], v196 offset:3072
    v_cvt_pk_bf16_f32 v84, v52, v53
    v_cvt_pk_bf16_f32 v85, v54, v55
    v_exp_f32 v56, v56
    v_exp_f32 v57, v57
    v_mfma_f32_32x32x16_bf16 v[116:131], v[180:183], v[92:95], v[116:131]
    ds_read_b128 v[164:167], v196 offset:16384
    v_exp_f32 v58, v58
    v_exp_f32 v59, v59
    v_cvt_pk_bf16_f32 v86, v56, v57
    v_cvt_pk_bf16_f32 v87, v58, v59
    v_mfma_f32_16x16x32_bf16 v[152:155], v[188:191], v[92:95], v[152:155]
    v_exp_f32 v60, v60
    v_exp_f32 v61, v61
    v_mfma_f32_32x32x16_bf16 v[116:131], v[184:187], v[96:99], v[116:131]
    ds_read_b128 v[168:171], v196 offset:17408
    v_exp_f32 v62, v62
    v_exp_f32 v63, v63
    v_exp_f32_e64 v64, v64
    v_cvt_pk_bf16_f32 v88, v60, v61
    v_mfma_f32_16x16x32_bf16 v[152:155], v[188:191], v[96:99], v[152:155]
    v_exp_f32_e64 v65, v65
    v_cvt_pk_bf16_f32 v89, v62, v63
    v_exp_f32 v66, v66
    v_exp_f32 v67, v67
    v_cvt_pk_bf16_f32 v90, v64, v65
    v_cvt_pk_bf16_f32 v91, v66, v67
    s_waitcnt lgkmcnt(0)
    s_nop 0
    v_mfma_f32_32x32x16_bf16 v[52:67], v[164:167], v[4:7], v[20:35]
    v_exp_f32 v68, v68
    v_exp_f32 v69, v69
    v_exp_f32 v70, v70
    v_exp_f32 v71, v71
    v_mfma_f32_32x32x16_bf16 v[52:67], v[168:171], v[8:11], v[52:67]
    v_cvt_pk_bf16_f32 v92, v68, v69
    v_cvt_pk_bf16_f32 v93, v70, v71
    v_exp_f32 v72, v72
    v_exp_f32 v73, v73
    v_mfma_f32_32x32x16_bf16 v[100:115], v[172:175], v[84:87], v[100:115]
    v_exp_f32 v74, v74
    v_exp_f32 v75, v75
    v_cvt_pk_bf16_f32 v94, v72, v73
    v_cvt_pk_bf16_f32 v95, v74, v75
    v_mfma_f32_16x16x32_bf16 v[148:151], v[188:191], v[84:87], v[148:151]
    v_exp_f32 v76, v76
    v_exp_f32 v77, v77
    v_mfma_f32_32x32x16_bf16 v[100:115], v[176:179], v[88:91], v[100:115]
    v_exp_f32 v78, v78
    v_exp_f32 v79, v79
    v_exp_f32_e64 v80, v80
    v_cvt_pk_bf16_f32 v96, v76, v77
    v_mfma_f32_16x16x32_bf16 v[148:151], v[188:191], v[88:91], v[148:151]
    v_exp_f32_e64 v81, v81
    v_cvt_pk_bf16_f32 v97, v78, v79
    v_exp_f32 v82, v82
    v_exp_f32 v83, v83
    v_cvt_pk_bf16_f32 v98, v80, v81
    v_cvt_pk_bf16_f32 v99, v82, v83
    s_bitcmp1_b32 s44, 0
    s_cbranch_scc1 L_hookL0
L_retL0:
    s_mov_b32 m0, s79
    s_nop 0
    buffer_load_dwordx4 v220, s[24:27], s39 offen  lds
    buffer_load_dwordx4 v221, s[24:27], s39 offen offset:1024  lds
    s_add_u32 m0, m0, 8192
    s_nop 0
    s_nop 0
    buffer_load_dwordx4 v220, s[4:7], s39 offen  lds
    buffer_load_dwordx4 v221, s[4:7], s39 offen offset:1024  lds
    s_add_u32 s39, s39, s36
    s_and_b32 s39, s39, s37
    s_waitcnt vmcnt(20)
    s_barrier
    v_mfma_f32_32x32x16_bf16 v[68:83], v[164:167], v[12:15], v[36:51]
    ds_read_b128 v[180:183], v196 offset:18432
    v_exp_f32 v52, v52
    v_exp_f32 v53, v53
    v_exp_f32 v54, v54
    v_exp_f32 v55, v55
    v_mfma_f32_32x32x16_bf16 v[68:83], v[168:171], v[16:19], v[68:83]
    ds_read_b128 v[184:187], v196 offset:19456
    v_cvt_pk_bf16_f32 v84, v52, v53
    v_cvt_pk_bf16_f32 v85, v54, v55
    v_exp_f32 v56, v56
    v_exp_f32 v57, v57
    v_mfma_f32_32x32x16_bf16 v[116:131], v[172:175], v[92:95], v[116:131]
    ds_read_b128 v[156:159], v196 offset:32768
    v_exp_f32 v58, v58
    v_exp_f32 v59, v59
    v_cvt_pk_bf16_f32 v86, v56, v57
    v_cvt_pk_bf16_f32 v87, v58, v59
    v_mfma_f32_16x16x32_bf16 v[152:155], v[188:191], v[92:95], v[152:155]
    v_exp_f32 v60, v60
    v_exp_f32 v61, v61
    v_mfma_f32_32x32x16_bf16 v[116:131], v[176:179], v[96:99], v[116:131]
    ds_read_b128 v[160:163], v196 offset:33792
    v_exp_f32 v62, v62
    v_exp_f32 v63, v63
    v_exp_f32_e64 v64, v64
    v_cvt_pk_bf16_f32 v88, v60, v61
    v_mfma_f32_16x16x32_bf16 v[152:155], v[188:191], v[96:99], v[152:155]
    v_exp_f32_e64 v65, v65
    v_cvt_pk_bf16_f32 v89, v62, v63
    v_exp_f32 v66, v66
    v_exp_f32 v67, v67
    v_cvt_pk_bf16_f32 v90, v64, v65
    v_cvt_pk_bf16_f32 v91, v66, v67
    s_waitcnt lgkmcnt(0)
    s_nop 0
    v_mfma_f32_32x32x16_bf16 v[52:67], v[156:159], v[4:7], v[20:35]
    v_exp_f32 v68, v68
    v_exp_f32 v69, v69
    v_exp_f32 v70, v70
    v_exp_f32 v71, v71
    v_mfma_f32_32x32x16_bf16 v[52:67], v[160:163], v[8:11], v[52:67]
    v_cvt_pk_bf16_f32 v92, v68, v69
    v_cvt_pk_bf16_f32 v93, v70, v71
    v_exp_f32 v72, v72
    v_exp_f32 v73, v73
    v_mfma_f32_32x32x16_bf16 v[100:115], v[180:183], v[84:87], v[100:115]
    v_exp_f32 v74, v74
    v_exp_f32 v75, v75
    v_cvt_pk_bf16_f32 v94, v72, v73
    v_cvt_pk_bf16_f32 v95, v74, v75
    v_mfma_f32_16x16x32_bf16 v[148:151], v[188:191], v[84:87], v[148:151]
    v_exp_f32 v76, v76
    v_exp_f32 v77, v77
    v_mfma_f32_32x32x16_bf16 v[100:115], v[184:187], v[88:91], v[100:115]
    v_exp_f32 v78, v78
    v_exp_f32 v79, v79
    v_exp_f32_e64 v80, v80
    v_cvt_pk_bf16_f32 v96, v76, v77
    v_mfma_f32_16x16x32_bf16 v[148:151], v[188:191], v[88:91], v[148:151]
    v_exp_f32_e64 v81, v81
    v_cvt_pk_bf16_f32 v97, v78, v79
    v_exp_f32 v82, v82
    v_exp_f32 v83, v83
    v_cvt_pk_bf16_f32 v98, v80, v81
    v_cvt_pk_bf16_f32 v99, v82, v83
    s_bitcmp1_b32 s44, 1
    s_cbranch_scc1 L_hookL1
L_retL1:
    s_mov_b32 m0, s72
    s_nop 0
    buffer_load_dwordx4 v220, s[24:27], s39 offen  lds
    buffer_load_dwordx4 v221, s[24:27], s39 offen offset:1024  lds
    s_add_u32 m0, m0, 8192
    s_nop 0
    s_nop 0
    buffer_load_dwordx4 v220, s[4:7], s39 offen  lds
    buffer_load_dwordx4 v221, s[4:7], s39 offen offset:1024  lds
    s_add_u32 s39, s39, s36
    s_and_b32 s39, s39, s37
    s_waitcnt vmcnt(20)
    s_barrier
    v_mfma_f32_32x32x16_bf16 v[68:83], v[156:159], v[12:15], v[36:51]
    ds_read_b128 v[172:175], v196 offset:34816
    v_exp_f32 v52, v52
    v_exp_f32 v53, v53
    v_exp_f32 v54, v54
    v_exp_f32 v55, v55
    v_mfma_f32_32x32x16_bf16 v[68:83], v[160:163], v[16:19], v[68:83]
    ds_read_b128 v[176:179], v196 offset:35840
    v_cvt_pk_bf16_f32 v84, v52, v53
    v_cvt_pk_bf16_f32 v85, v54, v55
    v_exp_f32 v56, v56
    v_exp_f32 v57, v57
    v_mfma_f32_32x32x16_bf16 v[116:131], v[180:183], v[92:95], v[116:131]
    ds_read_b128 v[164:167], v196 offset:49152
    v_exp_f32 v58, v58
    v_exp_f32 v59, v59
    v_cvt_pk_bf16_f32 v86, v56, v57
    v_cvt_pk_bf16_f32 v87, v58, v59
    v_mfma_f32_16x16x32_bf16 v[152:155], v[188:191], v[92:95], v[152:155]
    v_exp_f32 v60, v60
    v_exp_f32 v61, v61
    v_mfma_f32_32x32x16_bf16 v[116:131], v[184:187], v[96:99], v[116:131]
    ds_read_b128 v[168:171], v196 offset:50176
    v_exp_f32 v62, v62
    v_exp_f32 v63, v63
    v_exp_f32_e64 v64, v64
    v_cvt_pk_bf16_f32 v88, v60, v61
    v_mfma_f32_16x16x32_bf16 v[152:155], v[188:191], v[96:99], v[152:155]
    v_exp_f32_e64 v65, v65
    v_cvt_pk_bf16_f32 v89, v62, v63
    v_exp_f32 v66, v66
    v_exp_f32 v67, v67
    v_cvt_pk_bf16_f32 v90, v64, v65
    v_cvt_pk_bf16_f32 v91, v66, v67
    s_waitcnt lgkmcnt(0)
    s_nop 0
    v_mfma_f32_32x32x16_bf16 v[52:67], v[164:167], v[4:7], v[20:35]
    v_exp_f32 v68, v68
    v_exp_f32 v69, v69
    v_exp_f32 v70, v70
    v_exp_f32 v71, v71
    v_mfma_f32_32x32x16_bf16 v[52:67], v[168:171], v[8:11], v[52:67]
    v_cvt_pk_bf16_f32 v92, v68, v69
    v_cvt_pk_bf16_f32 v93, v70, v71
    v_exp_f32 v72, v72
    v_exp_f32 v73, v73
    v_mfma_f32_32x32x16_bf16 v[100:115], v[172:175], v[84:87], v[100:115]
    v_exp_f32 v74, v74
    v_exp_f32 v75, v75
    v_cvt_pk_bf16_f32 v94, v72, v73
    v_cvt_pk_bf16_f32 v95, v74, v75
    v_mfma_f32_16x16x32_bf16 v[148:151], v[188:191], v[84:87], v[148:151]
    v_exp_f32 v76, v76
    v_exp_f32 v77, v77
    v_mfma_f32_32x32x16_bf16 v[100:115], v[176:179], v[88:91], v[100:115]
    v_exp_f32 v78, v78
    v_exp_f32 v79, v79
    v_exp_f32_e64 v80, v80
    v_cvt_pk_bf16_f32 v96, v76, v77
    v_mfma_f32_16x16x32_bf16 v[148:151], v[188:191], v[88:91], v[148:151]
    v_exp_f32_e64 v81, v81
    v_cvt_pk_bf16_f32 v97, v78, v79
    v_exp_f32 v82, v82
    v_exp_f32 v83, v83
    v_cvt_pk_bf16_f32 v98, v80, v81
    v_cvt_pk_bf16_f32 v99, v82, v83
    s_bitcmp1_b32 s44, 2
    s_cbranch_scc1 L_hookL2
L_retL2:
    s_mov_b32 m0, s73
    s_nop 0
    buffer_load_dwordx4 v220, s[24:27], s39 offen  lds
    buffer_load_dwordx4 v221, s[24:27], s39 offen offset:1024  lds
    s_add_u32 m0, m0, 8192
    s_nop 0
    s_nop 0
    buffer_load_dwordx4 v220, s[4:7], s39 offen  lds
    buffer_load_dwordx4 v221, s[4:7], s39 offen offset:1024  lds
    s_add_u32 s39, s39, s36
    s_and_b32 s39, s39, s37
    s_waitcnt vmcnt(20)
    s_barrier
    v_mfma_f32_32x32x16_bf16 v[68:83], v[164:167], v[12:15], v[36:51]
    ds_read_b128 v[180:183], v196 offset:51200
    v_exp_f32 v52, v52
    v_exp_f32 v53, v53
    v_exp_f32 v54, v54
    v_exp_f32 v55, v55
    v_mfma_f32_32x32x16_bf16 v[68:83], v[168:171], v[16:19], v[68:83]
    ds_read_b128 v[184:187], v196 offset:52224
    v_cvt_pk_bf16_f32 v84, v52, v53
    v_cvt_pk_bf16_f32 v85, v54, v55
    v_exp_f32 v56, v56
    v_exp_f32 v57, v57
    v_mfma_f32_32x32x16_bf16 v[116:131], v[172:175], v[92:95], v[116:131]
    ds_read_b128 v[156:159], v197 offset:0
    v_exp_f32 v58, v58
    v_exp_f32 v59, v59
    v_cvt_pk_bf16_f32 v86, v56, v57
    v_cvt_pk_bf16_f32 v87, v58, v59
    v_mfma_f32_16x16x32_bf16 v[152:155], v[188:191], v[92:95], v[152:155]
    v_exp_f32 v60, v60
    v_exp_f32 v61, v61
    v_mfma_f32_32x32x16_bf16 v[116:131], v[176:179], v[96:99], v[116:131]
    ds_read_b128 v[160:163], v197 offset:1024
    v_exp_f32 v62, v62
    v_exp_f32 v63, v63
    v_exp_f32_e64 v64, v64
    v_cvt_pk_bf16_f32 v88, v60, v61
    v_mfma_f32_16x16x32_bf16 v[152:155], v[188:191], v[96:99], v[152:155]
    v_exp_f32_e64 v65, v65
    v_cvt_pk_bf16_f32 v89, v62, v63
    v_exp_f32 v66, v66
    v_exp_f32 v67, v67
    v_cvt_pk_bf16_f32 v90, v64, v65
    v_cvt_pk_bf16_f32 v91, v66, v67
    s_waitcnt lgkmcnt(0)
    s_nop 0
    v_mfma_f32_32x32x16_bf16 v[52:67], v[156:159], v[4:7], v[20:35]
    v_exp_f32 v68, v68
    v_exp_f32 v69, v69
    v_exp_f32 v70, v70
    v_exp_f32 v71, v71
    v_mfma_f32_32x32x16_bf16 v[52:67], v[160:163], v[8:11], v[52:67]
    v_cvt_pk_bf16_f32 v92, v68, v69
    v_cvt_pk_bf16_f32 v93, v70, v71
    v_exp_f32 v72, v72
    v_exp_f32 v73, v73
    v_mfma_f32_32x32x16_bf16 v[100:115], v[180:183], v[84:87], v[100:115]
    v_exp_f32 v74, v74
    v_exp_f32 v75, v75
    v_cvt_pk_bf16_f32 v94, v72, v73
    v_cvt_pk_bf16_f32 v95, v74, v75
    v_mfma_f32_16x16x32_bf16 v[148:151], v[188:191], v[84:87], v[148:151]
    v_exp_f32 v76, v76
    v_exp_f32 v77, v77
    v_mfma_f32_32x32x16_bf16 v[100:115], v[184:187], v[88:91], v[100:115]
    v_exp_f32 v78, v78
    v_exp_f32 v79, v79
    v_exp_f32_e64 v80, v80
    v_cvt_pk_bf16_f32 v96, v76, v77
    v_mfma_f32_16x16x32_bf16 v[148:151], v[188:191], v[88:91], v[148:151]
    v_exp_f32_e64 v81, v81
    v_cvt_pk_bf16_f32 v97, v78, v79
    v_exp_f32 v82, v82
    v_exp_f32 v83, v83
    v_cvt_pk_bf16_f32 v98, v80, v81
    v_cvt_pk_bf16_f32 v99, v82, v83
    s_bitcmp1_b32 s44, 3
    s_cbranch_scc1 L_hookL3
L_retL3:
    s_mov_b32 m0, s74
    s_nop 0
    buffer_load_dwordx4 v220, s[24:27], s39 offen  lds
    buffer_load_dwordx4 v221, s[24:27], s39 offen offset:1024  lds
    s_add_u32 m0, m0, 8192
    s_nop 0
    s_nop 0
    buffer_load_dwordx4 v220, s[4:7], s39 offen  lds
    buffer_load_dwordx4 v221, s[4:7], s39 offen offset:1024  lds
    s_add_u32 s39, s39, s36
    s_and_b32 s39, s39, s37
    s_waitcnt vmcnt(20)
    s_barrier
    v_mfma_f32_32x32x16_bf16 v[68:83], v[156:159], v[12:15], v[36:51]
    ds_read_b128 v[172:175], v197 offset:2048
    v_exp_f32 v52, v52
    v_exp_f32 v53, v53
    v_exp_f32 v54, v54
    v_exp_f32 v55, v55
    v_mfma_f32_32x32x16_bf16 v[68:83], v[160:163], v[16:19], v[68:83]
    ds_read_b128 v[176:179], v197 offset:3072
    v_cvt_pk_bf16_f32 v84, v52, v53
    v_cvt_pk_bf16_f32 v85, v54, v55
    v_exp_f32 v56, v56
    v_exp_f32 v57, v57
    v_mfma_f32_32x32x16_bf16 v[116:131], v[180:183], v[92:95], v[116:131]
    ds_read_b128 v[164:167], v197 offset:16384
    v_exp_f32 v58, v58
    v_exp_f32 v59, v59
    v_cvt_pk_bf16_f32 v86, v56, v57
    v_cvt_pk_bf16_f32 v87, v58, v59
    v_mfma_f32_16x16x32_bf16 v[152:155], v[188:191], v[92:95], v[152:155]
    v_exp_f32 v60, v60
    v_exp_f32 v61, v61
    v_mfma_f32_32x32x16_bf16 v[116:131], v[184:187], v[96:99], v[116:131]
    ds_read_b128 v[168:171], v197 offset:17408
    v_exp_f32 v62, v62
    v_exp_f32 v63, v63
    v_exp_f32_e64 v64, v64
    v_cvt_pk_bf16_f32 v88, v60, v61
    v_mfma_f32_16x16x32_bf16 v[152:155], v[188:191], v[96:99], v[152:155]
    v_exp_f32_e64 v65, v65
    v_cvt_pk_bf16_f32 v89, v62, v63
    v_exp_f32 v66, v66
    v_exp_f32 v67, v67
    v_cvt_pk_bf16_f32 v90, v64, v65
    v_cvt_pk_bf16_f32 v91, v66, v67
    s_waitcnt lgkmcnt(0)
    s_nop 0
    v_mfma_f32_32x32x16_bf16 v[52:67], v[164:167], v[4:7], v[20:35]
    v_exp_f32 v68, v68
    v_exp_f32 v69, v69
    v_exp_f32 v70, v70
    v_exp_f32 v71, v71
    v_mfma_f32_32x32x16_bf16 v[52:67], v[168:171], v[8:11], v[52:67]
    v_cvt_pk_bf16_f32 v92, v68, v69
    v_cvt_pk_bf16_f32 v93, v70, v71
    v_exp_f32 v72, v72
    v_exp_f32 v73, v73
    v_mfma_f32_32x32x16_bf16 v[100:115], v[172:175], v[84:87], v[100:115]
    v_exp_f32 v74, v74
    v_exp_f32 v75, v75
    v_cvt_pk_bf16_f32 v94, v72, v73
    v_cvt_pk_bf16_f32 v95, v74, v75
    v_mfma_f32_16x16x32_bf16 v[148:151], v[188:191], v[84:87], v[148:151]
    v_exp_f32 v76, v76
    v_exp_f32 v77, v77
    v_mfma_f32_32x32x16_bf16 v[100:115], v[176:179], v[88:91], v[100:115]
    v_exp_f32 v78, v78
    v_exp_f32 v79, v79
    v_exp_f32_e64 v80, v80
    v_cvt_pk_bf16_f32 v96, v76, v77
    v_mfma_f32_16x16x32_bf16 v[148:151], v[188:191], v[88:91], v[148:151]
    v_exp_f32_e64 v81, v81
    v_cvt_pk_bf16_f32 v97, v78, v79
    v_exp_f32 v82, v82
    v_exp_f32 v83, v83
    v_cvt_pk_bf16_f32 v98, v80, v81
    v_cvt_pk_bf16_f32 v99, v82, v83
    s_mov_b32 m0, s75
    s_nop 0
    buffer_load_dwordx4 v220, s[24:27], s39 offen  lds
    buffer_load_dwordx4 v221, s[24:27], s39 offen offset:1024  lds
    s_add_u32 m0, m0, 8192
    s_nop 0
    s_nop 0
    buffer_load_dwordx4 v220, s[4:7], s39 offen  lds
    buffer_load_dwordx4 v221, s[4:7], s39 offen offset:1024  lds
    s_add_u32 s39, s39, s36
    s_and_b32 s39, s39, s37
    s_waitcnt vmcnt(20)
    s_barrier
    v_mfma_f32_32x32x16_bf16 v[68:83], v[164:167], v[12:15], v[36:51]
    ds_read_b128 v[180:183], v197 offset:18432
    v_exp_f32 v52, v52
    v_exp_f32 v53, v53
    v_exp_f32 v54, v54
    v_exp_f32 v55, v55
    v_mfma_f32_32x32x16_bf16 v[68:83], v[168:171], v[16:19], v[68:83]
    ds_read_b128 v[184:187], v197 offset:19456
    v_cvt_pk_bf16_f32 v84, v52, v53
    v_cvt_pk_bf16_f32 v85, v54, v55
    v_exp_f32 v56, v56
    v_exp_f32 v57, v57
    v_mfma_f32_32x32x16_bf16 v[116:131], v[172:175], v[92:95], v[116:131]
    ds_read_b128 v[156:159], v197 offset:32768
    v_exp_f32 v58, v58
    v_exp_f32 v59, v59
    v_cvt_pk_bf16_f32 v86, v56, v57
    v_cvt_pk_bf16_f32 v87, v58, v59
    v_mfma_f32_16x16x32_bf16 v[152:155], v[188:191], v[92:95], v[152:155]
    v_exp_f32 v60, v60
    v_exp_f32 v61, v61
    v_mfma_f32_32x32x16_bf16 v[116:131], v[176:179], v[96:99], v[116:131]
    ds_read_b128 v[160:163], v197 offset:33792
    v_exp_f32 v62, v62
    v_exp_f32 v63, v63
    v_exp_f32_e64 v64, v64
    v_cvt_pk_bf16_f32 v88, v60, v61
    v_mfma_f32_16x16x32_bf16 v[152:155], v[188:191], v[96:99], v[152:155]
    v_exp_f32_e64 v65, v65
    v_cvt_pk_bf16_f32 v89, v62, v63
    v_exp_f32 v66, v66
    v_exp_f32 v67, v67
    v_cvt_pk_bf16_f32 v90, v64, v65
    v_cvt_pk_bf16_f32 v91, v66, v67
    s_waitcnt lgkmcnt(0)
    s_nop 0
    v_mfma_f32_32x32x16_bf16 v[52:67], v[156:159], v[4:7], v[20:35]
    v_exp_f32 v68, v68
    v_exp_f32 v69, v69
    v_exp_f32 v70, v70
    v_exp_f32 v71, v71
    v_mfma_f32_32x32x16_bf16 v[52:67], v[160:163], v[8:11], v[52:67]
    v_cvt_pk_bf16_f32 v92, v68, v69
    v_cvt_pk_bf16_f32 v93, v70, v71
    v_exp_f32 v72, v72
    v_exp_f32 v73, v73
    v_mfma_f32_32x32x16_bf16 v[100:115], v[180:183], v[84:87], v[100:115]
    v_exp_f32 v74, v74
    v_exp_f32 v75, v75
    v_cvt_pk_bf16_f32 v94, v72, v73
    v_cvt_pk_bf16_f32 v95, v74, v75
    v_mfma_f32_16x16x32_bf16 v[148:151], v[188:191], v[84:87], v[148:151]
    v_exp_f32 v76, v76
    v_exp_f32 v77, v77
    v_mfma_f32_32x32x16_bf16 v[100:115], v[184:187], v[88:91], v[100:115]
    v_exp_f32 v78, v78
    v_exp_f32 v79, v79
    v_exp_f32_e64 v80, v80
    v_cvt_pk_bf16_f32 v96, v76, v77
    v_mfma_f32_16x16x32_bf16 v[148:151], v[188:191], v[88:91], v[148:151]
    v_exp_f32_e64 v81, v81
    v_cvt_pk_bf16_f32 v97, v78, v79
    v_exp_f32 v82, v82
    v_exp_f32 v83, v83
    v_cvt_pk_bf16_f32 v98, v80, v81
    v_cvt_pk_bf16_f32 v99, v82, v83
    s_bitcmp1_b32 s44, 5
    s_cbranch_scc1 L_hookL5
L_retL5:
    s_mov_b32 m0, s76
    s_nop 0
    buffer_load_dwordx4 v220, s[24:27], s39 offen  lds
    buffer_load_dwordx4 v221, s[24:27], s39 offen offset:1024  lds
    s_add_u32 m0, m0, 8192
    s_nop 0
    s_nop 0
    buffer_load_dwordx4 v220, s[4:7], s39 offen  lds
    buffer_load_dwordx4 v221, s[4:7], s39 offen offset:1024  lds
    s_add_u32 s39, s39, s36
    s_and_b32 s39, s39, s37
    s_waitcnt vmcnt(20)
    s_barrier
    v_mfma_f32_32x32x16_bf16 v[68:83], v[156:159], v[12:15], v[36:51]
    ds_read_b128 v[172:175], v197 offset:34816
    v_exp_f32 v52, v52
    v_exp_f32 v53, v53
    v_exp_f32 v54, v54
    v_exp_f32 v55, v55
    v_mfma_f32_32x32x16_bf16 v[68:83], v[160:163], v[16:19], v[68:83]
    ds_read_b128 v[176:179], v197 offset:35840
    v_cvt_pk_bf16_f32 v84, v52, v53
    v_cvt_pk_bf16_f32 v85, v54, v55
    v_exp_f32 v56, v56
    v_exp_f32 v57, v57
    v_mfma_f32_32x32x16_bf16 v[116:131], v[180:183], v[92:95], v[116:131]
    ds_read_b128 v[164:167], v197 offset:49152
    v_exp_f32 v58, v58
    v_exp_f32 v59, v59
    v_cvt_pk_bf16_f32 v86, v56, v57
    v_cvt_pk_bf16_f32 v87, v58, v59
    v_mfma_f32_16x16x32_bf16 v[152:155], v[188:191], v[92:95], v[152:155]
    v_exp_f32 v60, v60
    v_exp_f32 v61, v61
    v_mfma_f32_32x32x16_bf16 v[116:131], v[184:187], v[96:99], v[116:131]
    ds_read_b128 v[168:171], v197 offset:50176
    v_exp_f32 v62, v62
    v_exp_f32 v63, v63
    v_exp_f32_e64 v64, v64
    v_cvt_pk_bf16_f32 v88, v60, v61
    v_mfma_f32_16x16x32_bf16 v[152:155], v[188:191], v[96:99], v[152:155]
    v_exp_f32_e64 v65, v65
    v_cvt_pk_bf16_f32 v89, v62, v63
    v_exp_f32 v66, v66
    v_exp_f32 v67, v67
    v_cvt_pk_bf16_f32 v90, v64, v65
    v_cvt_pk_bf16_f32 v91, v66, v67
    s_waitcnt lgkmcnt(0)
    s_nop 0
    v_mfma_f32_32x32x16_bf16 v[52:67], v[164:167], v[4:7], v[20:35]
    v_exp_f32 v68, v68
    v_exp_f32 v69, v69
    v_exp_f32 v70, v70
    v_exp_f32 v71, v71
    v_mfma_f32_32x32x16_bf16 v[52:67], v[168:171], v[8:11], v[52:67]
    v_cvt_pk_bf16_f32 v92, v68, v69
    v_cvt_pk_bf16_f32 v93, v70, v71
    v_exp_f32 v72, v72
    v_exp_f32 v73, v73
    v_mfma_f32_32x32x16_bf16 v[100:115], v[172:175], v[84:87], v[100:115]
    v_exp_f32 v74, v74
    v_exp_f32 v75, v75
    v_cvt_pk_bf16_f32 v94, v72, v73
    v_cvt_pk_bf16_f32 v95, v74, v75
    v_mfma_f32_16x16x32_bf16 v[148:151], v[188:191], v[84:87], v[148:151]
    v_exp_f32 v76, v76
    v_exp_f32 v77, v77
    v_mfma_f32_32x32x16_bf16 v[100:115], v[176:179], v[88:91], v[100:115]
    v_exp_f32 v78, v78
    v_exp_f32 v79, v79
    v_exp_f32_e64 v80, v80
    v_cvt_pk_bf16_f32 v96, v76, v77
    v_mfma_f32_16x16x32_bf16 v[148:151], v[188:191], v[88:91], v[148:151]
    v_exp_f32_e64 v81, v81
    v_cvt_pk_bf16_f32 v97, v78, v79
    v_exp_f32 v82, v82
    v_exp_f32 v83, v83
    v_cvt_pk_bf16_f32 v98, v80, v81
    v_cvt_pk_bf16_f32 v99, v82, v83
    s_bitcmp1_b32 s44, 6
    s_cbranch_scc1 L_hookL6
L_retL6:
    s_mov_b32 m0, s77
    s_nop 0
    buffer_load_dwordx4 v220, s[24:27], s39 offen  lds
    buffer_load_dwordx4 v221, s[24:27], s39 offen offset:1024  lds
    s_add_u32 m0, m0, 8192
    s_nop 0
    s_nop 0
    buffer_load_dwordx4 v220, s[4:7], s39 offen  lds
    buffer_load_dwordx4 v221, s[4:7], s39 offen offset:1024  lds
    s_add_u32 s39, s39, s36
    s_and_b32 s39, s39, s37
    s_waitcnt vmcnt(20)
    s_barrier
    v_mfma_f32_32x32x16_bf16 v[68:83], v[164:167], v[12:15], v[36:51]
    ds_read_b128 v[180:183], v197 offset:51200
    v_exp_f32 v52, v52
    v_exp_f32 v53, v53
    v_exp_f32 v54, v54
    v_exp_f32 v55, v55
    v_mfma_f32_32x32x16_bf16 v[68:83], v[168:171], v[16:19], v[68:83]
    ds_read_b128 v[184:187], v197 offset:52224
    v_cvt_pk_bf16_f32 v84, v52, v53
    v_cvt_pk_bf16_f32 v85, v54, v55
    v_exp_f32 v56, v56
    v_exp_f32 v57, v57
    v_mfma_f32_32x32x16_bf16 v[116:131], v[172:175], v[92:95], v[116:131]
    ds_read_b128 v[156:159], v196 offset:0
    v_exp_f32 v58, v58
    v_exp_f32 v59, v59
    v_cvt_pk_bf16_f32 v86, v56, v57
    v_cvt_pk_bf16_f32 v87, v58, v59
    v_mfma_f32_16x16x32_bf16 v[152:155], v[188:191], v[92:95], v[152:155]
    v_exp_f32 v60, v60
    v_exp_f32 v61, v61
    v_mfma_f32_32x32x16_bf16 v[116:131], v[176:179], v[96:99], v[116:131]
    ds_read_b128 v[160:163], v196 offset:1024
    v_exp_f32 v62, v62
    v_exp_f32 v63, v63
    v_exp_f32_e64 v64, v64
    v_cvt_pk_bf16_f32 v88, v60, v61
    v_mfma_f32_16x16x32_bf16 v[152:155], v[188:191], v[96:99], v[152:155]
    v_exp_f32_e64 v65, v65
    v_cvt_pk_bf16_f32 v89, v62, v63
    v_exp_f32 v66, v66
    v_exp_f32 v67, v67
    v_cvt_pk_bf16_f32 v90, v64, v65
    v_cvt_pk_bf16_f32 v91, v66, v67
    s_waitcnt lgkmcnt(0)
    s_nop 0
    v_mfma_f32_32x32x16_bf16 v[52:67], v[156:159], v[4:7], v[20:35]
    v_exp_f32 v68, v68
    v_exp_f32 v69, v69
    v_exp_f32 v70, v70
    v_exp_f32 v71, v71
    v_mfma_f32_32x32x16_bf16 v[52:67], v[160:163], v[8:11], v[52:67]
    v_cvt_pk_bf16_f32 v92, v68, v69
    v_cvt_pk_bf16_f32 v93, v70, v71
    v_exp_f32 v72, v72
    v_exp_f32 v73, v73
    v_mfma_f32_32x32x16_bf16 v[100:115], v[180:183], v[84:87], v[100:115]
    v_exp_f32 v74, v74
    v_exp_f32 v75, v75
    v_cvt_pk_bf16_f32 v94, v72, v73
    v_cvt_pk_bf16_f32 v95, v74, v75
    v_mfma_f32_16x16x32_bf16 v[148:151], v[188:191], v[84:87], v[148:151]
    v_exp_f32 v76, v76
    v_exp_f32 v77, v77
    v_mfma_f32_32x32x16_bf16 v[100:115], v[184:187], v[88:91], v[100:115]
    v_exp_f32 v78, v78
    v_exp_f32 v79, v79
    v_exp_f32_e64 v80, v80
    v_cvt_pk_bf16_f32 v96, v76, v77
    v_mfma_f32_16x16x32_bf16 v[148:151], v[188:191], v[88:91], v[148:151]
    v_exp_f32_e64 v81, v81
    v_cvt_pk_bf16_f32 v97, v78, v79
    v_exp_f32 v82, v82
    v_exp_f32 v83, v83
    v_cvt_pk_bf16_f32 v98, v80, v81
    v_cvt_pk_bf16_f32 v99, v82, v83
    s_bitcmp1_b32 s44, 7
    s_cbranch_scc1 L_hookL7
L_retL7:
    s_mov_b32 m0, s78
    s_nop 0
    buffer_load_dwordx4 v220, s[24:27], s39 offen  lds
    buffer_load_dwordx4 v221, s[24:27], s39 offen offset:1024  lds
    s_add_u32 m0, m0, 8192
    s_nop 0
    s_nop 0
    buffer_load_dwordx4 v220, s[4:7], s39 offen  lds
    buffer_load_dwordx4 v221, s[4:7], s39 offen offset:1024  lds
    s_add_u32 s39, s39, s36
    s_and_b32 s39, s39, s37
    s_lshr_b32 s44, s44, 8
    s_add_u32 s35, s35, 1
    s_cmp_lt_u32 s35, 4
    s_cbranch_scc1 L_mainL
    v_mfma_f32_32x32x16_bf16 v[116:131], v[180:183], v[92:95], v[116:131]
    v_mfma_f32_16x16x32_bf16 v[152:155], v[188:191], v[92:95], v[152:155]
    v_mfma_f32_32x32x16_bf16 v[116:131], v[184:187], v[96:99], v[116:131]
    v_mfma_f32_16x16x32_bf16 v[152:155], v[188:191], v[96:99], v[152:155]
    s_setprio 0
    s_branch L_attn_end
L_mainF:
    s_barrier
    s_nop 0
    v_mfma_f32_32x32x16_bf16 v[68:83], v[156:159], v[12:15], v[36:51]
    ds_read_b128 v[172:175], v196 offset:2048
    v_exp_f32 v52, v52
    v_exp_f32 v53, v53
    v_exp_f32 v54, v54
    v_exp_f32 v55, v55
    v_mfma_f32_32x32x16_bf16 v[68:83], v[160:163], v[16:19], v[68:83]
    ds_read_b128 v[176:179], v196 offset:3072
    v_cvt_pk_bf16_f32 v84, v52, v53
    v_cvt_pk_bf16_f32 v85, v54, v55
    v_exp_f32 v56, v56
    v_exp_f32 v57, v57
    v_mfma_f32_32x32x16_bf16 v[116:131], v[180:183], v[92:95], v[116:131]
    ds_read_b128 v[164:167], v196 offset:16384
    v_exp_f32 v58, v58
    v_exp_f32 v59, v59
    v_cvt_pk_bf16_f32 v86, v56, v57
    v_cvt_pk_bf16_f32 v87, v58, v59
    v_mfma_f32_16x16x32_bf16 v[152:155], v[188:191], v[92:95], v[152:155]
    v_exp_f32 v60, v60
    v_exp_f32 v61, v61
    v_mfma_f32_32x32x16_bf16 v[116:131], v[184:187], v[96:99], v[116:131]
    ds_read_b128 v[168:171], v196 offset:17408
    v_exp_f32 v62, v62
    v_exp_f32 v63, v63
    v_exp_f32_e64 v64, v64
    v_cvt_pk_bf16_f32 v88, v60, v61
    v_mfma_f32_16x16x32_bf16 v[152:155], v[188:191], v[96:99], v[152:155]
    v_exp_f32_e64 v65, v65
    v_cvt_pk_bf16_f32 v89, v62, v63
    v_exp_f32 v66, v66
    v_exp_f32 v67, v67
    v_cvt_pk_bf16_f32 v90, v64, v65
    v_cvt_pk_bf16_f32 v91, v66, v67
    s_waitcnt lgkmcnt(0)
    s_nop 0
    v_mfma_f32_32x32x16_bf16 v[52:67], v[164:167], v[4:7], v[20:35]
    v_exp_f32 v68, v68
    v_exp_f32 v69, v69
    v_exp_f32 v70, v70
    v_exp_f32 v71, v71
    v_mfma_f32_32x32x16_bf16 v[52:67], v[168:171], v[8:11], v[52:67]
    v_cvt_pk_bf16_f32 v92, v68, v69
    v_cvt_pk_bf16_f32 v93, v70, v71
    v_exp_f32 v72, v72
    v_exp_f32 v73, v73
    v_mfma_f32_32x32x16_bf16 v[100:115], v[172:175], v[84:87], v[100:115]
    v_exp_f32 v74, v74
    v_exp_f32 v75, v75
    v_cvt_pk_bf16_f32 v94, v72, v73
    v_cvt_pk_bf16_f32 v95, v74, v75
    v_mfma_f32_16x16x32_bf16 v[148:151], v[188:191], v[84:87], v[148:151]
    v_exp_f32 v76, v76
    v_exp_f32 v77, v77
    v_mfma_f32_32x32x16_bf16 v[100:115], v[176:179], v[88:91], v[100:115]
    v_exp_f32 v78, v78
    v_exp_f32 v79, v79
    v_exp_f32_e64 v80, v80
    v_cvt_pk_bf16_f32 v96, v76, v77
    v_mfma_f32_16x16x32_bf16 v[148:151], v[188:191], v[88:91], v[148:151]
    v_exp_f32_e64 v81, v81
    v_cvt_pk_bf16_f32 v97, v78, v79
    v_exp_f32 v82, v82
    v_exp_f32 v83, v83
    v_cvt_pk_bf16_f32 v98, v80, v81
    v_cvt_pk_bf16_f32 v99, v82, v83
    s_bitcmp1_b32 s44, 0
    s_cbranch_scc1 L_hookF0
L_retF0:
    s_barrier
    s_nop 0
    v_mfma_f32_32x32x16_bf16 v[68:83], v[164:167], v[12:15], v[36:51]
    ds_read_b128 v[180:183], v196 offset:18432
    v_exp_f32 v52, v52
    v_exp_f32 v53, v53
    v_exp_f32 v54, v54
    v_exp_f32 v55, v55
    v_mfma_f32_32x32x16_bf16 v[68:83], v[168:171], v[16:19], v[68:83]
    ds_read_b128 v[184:187], v196 offset:19456
    v_cvt_pk_bf16_f32 v84, v52, v53
    v_cvt_pk_bf16_f32 v85, v54, v55
    v_exp_f32 v56, v56
    v_exp_f32 v57, v57
    v_mfma_f32_32x32x16_bf16 v[116:131], v[172:175], v[92:95], v[116:131]
    ds_read_b128 v[156:159], v196 offset:32768
    v_exp_f32 v58, v58
    v_exp_f32 v59, v59
    v_cvt_pk_bf16_f32 v86, v56, v57
    v_cvt_pk_bf16_f32 v87, v58, v59
    v_mfma_f32_16x16x32_bf16 v[152:155], v[188:191], v[92:95], v[152:155]
    v_exp_f32 v60, v60
    v_exp_f32 v61, v61
    v_mfma_f32_32x32x16_bf16 v[116:131], v[176:179], v[96:99], v[116:131]
    ds_read_b128 v[160:163], v196 offset:33792
    v_exp_f32 v62, v62
    v_exp_f32 v63, v63
    v_exp_f32_e64 v64, v64
    v_cvt_pk_bf16_f32 v88, v60, v61
    v_mfma_f32_16x16x32_bf16 v[152:155], v[188:191], v[96:99], v[152:155]
    v_exp_f32_e64 v65, v65
    v_cvt_pk_bf16_f32 v89, v62, v63
    v_exp_f32 v66, v66
    v_exp_f32 v67, v67
    v_cvt_pk_bf16_f32 v90, v64, v65
    v_cvt_pk_bf16_f32 v91, v66, v67
    s_waitcnt lgkmcnt(0)
    s_nop 0
    v_mfma_f32_32x32x16_bf16 v[52:67], v[156:159], v[4:7], v[20:35]
    v_exp_f32 v68, v68
    v_exp_f32 v69, v69
    v_exp_f32 v70, v70
    v_exp_f32 v71, v71
    v_mfma_f32_32x32x16_bf16 v[52:67], v[160:163], v[8:11], v[52:67]
    v_cvt_pk_bf16_f32 v92, v68, v69
    v_cvt_pk_bf16_f32 v93, v70, v71
    v_exp_f32 v72, v72
    v_exp_f32 v73, v73
    v_mfma_f32_32x32x16_bf16 v[100:115], v[180:183], v[84:87], v[100:115]
    v_exp_f32 v74, v74
    v_exp_f32 v75, v75
    v_cvt_pk_bf16_f32 v94, v72, v73
    v_cvt_pk_bf16_f32 v95, v74, v75
    v_mfma_f32_16x16x32_bf16 v[148:151], v[188:191], v[84:87], v[148:151]
    v_exp_f32 v76, v76
    v_exp_f32 v77, v77
    v_mfma_f32_32x32x16_bf16 v[100:115], v[184:187], v[88:91], v[100:115]
    v_exp_f32 v78, v78
    v_exp_f32 v79, v79
    v_exp_f32_e64 v80, v80
    v_cvt_pk_bf16_f32 v96, v76, v77
    v_mfma_f32_16x16x32_bf16 v[148:151], v[188:191], v[88:91], v[148:151]
    v_exp_f32_e64 v81, v81
    v_cvt_pk_bf16_f32 v97, v78, v79
    v_exp_f32 v82, v82
    v_exp_f32 v83, v83
    v_cvt_pk_bf16_f32 v98, v80, v81
    v_cvt_pk_bf16_f32 v99, v82, v83
    s_barrier
    s_nop 0
    v_mfma_f32_32x32x16_bf16 v[68:83], v[156:159], v[12:15], v[36:51]
    ds_read_b128 v[172:175], v196 offset:34816
    v_exp_f32 v52, v52
    v_exp_f32 v53, v53
    v_exp_f32 v54, v54
    v_exp_f32 v55, v55
    v_mfma_f32_32x32x16_bf16 v[68:83], v[160:163], v[16:19], v[68:83]
    ds_read_b128 v[176:179], v196 offset:35840
    v_cvt_pk_bf16_f32 v84, v52, v53
    v_cvt_pk_bf16_f32 v85, v54, v55
    v_exp_f32 v56, v56
    v_exp_f32 v57, v57
    v_mfma_f32_32x32x16_bf16 v[116:131], v[180:183], v[92:95], v[116:131]
    ds_read_b128 v[164:167], v196 offset:49152
    v_exp_f32 v58, v58
    v_exp_f32 v59, v59
    v_cvt_pk_bf16_f32 v86, v56, v57
    v_cvt_pk_bf16_f32 v87, v58, v59
    v_mfma_f32_16x16x32_bf16 v[152:155], v[188:191], v[92:95], v[152:155]
    v_exp_f32 v60, v60
    v_exp_f32 v61, v61
    v_mfma_f32_32x32x16_bf16 v[116:131], v[184:187], v[96:99], v[116:131]
    ds_read_b128 v[168:171], v196 offset:50176
    v_exp_f32 v62, v62
    v_exp_f32 v63, v63
    v_exp_f32_e64 v64, v64
    v_cvt_pk_bf16_f32 v88, v60, v61
    v_mfma_f32_16x16x32_bf16 v[152:155], v[188:191], v[96:99], v[152:155]
    v_exp_f32_e64 v65, v65
    v_cvt_pk_bf16_f32 v89, v62, v63
    v_exp_f32 v66, v66
    v_exp_f32 v67, v67
    v_cvt_pk_bf16_f32 v90, v64, v65
    v_cvt_pk_bf16_f32 v91, v66, v67
    s_waitcnt lgkmcnt(0)
    s_nop 0
    v_mfma_f32_32x32x16_bf16 v[52:67], v[164:167], v[4:7], v[20:35]
    v_exp_f32 v68, v68
    v_exp_f32 v69, v69
    v_exp_f32 v70, v70
    v_exp_f32 v71, v71
    v_mfma_f32_32x32x16_bf16 v[52:67], v[168:171], v[8:11], v[52:67]
    v_cvt_pk_bf16_f32 v92, v68, v69
    v_cvt_pk_bf16_f32 v93, v70, v71
    v_exp_f32 v72, v72
    v_exp_f32 v73, v73
    v_mfma_f32_32x32x16_bf16 v[100:115], v[172:175], v[84:87], v[100:115]
    v_exp_f32 v74, v74
    v_exp_f32 v75, v75
    v_cvt_pk_bf16_f32 v94, v72, v73
    v_cvt_pk_bf16_f32 v95, v74, v75
    v_mfma_f32_16x16x32_bf16 v[148:151], v[188:191], v[84:87], v[148:151]
    v_exp_f32 v76, v76
    v_exp_f32 v77, v77
    v_mfma_f32_32x32x16_bf16 v[100:115], v[176:179], v[88:91], v[100:115]
    v_exp_f32 v78, v78
    v_exp_f32 v79, v79
    v_exp_f32_e64 v80, v80
    v_cvt_pk_bf16_f32 v96, v76, v77
    v_mfma_f32_16x16x32_bf16 v[148:151], v[188:191], v[88:91], v[148:151]
    v_exp_f32_e64 v81, v81
    v_cvt_pk_bf16_f32 v97, v78, v79
    v_exp_f32 v82, v82
    v_exp_f32 v83, v83
    v_cvt_pk_bf16_f32 v98, v80, v81
    v_cvt_pk_bf16_f32 v99, v82, v83
    s_barrier
    s_nop 0
    v_mfma_f32_32x32x16_bf16 v[68:83], v[164:167], v[12:15], v[36:51]
    ds_read_b128 v[180:183], v196 offset:51200
    v_exp_f32 v52, v52
    v_exp_f32 v53, v53
    v_exp_f32 v54, v54
    v_exp_f32 v55, v55
    v_mfma_f32_32x32x16_bf16 v[68:83], v[168:171], v[16:19], v[68:83]
    ds_read_b128 v[184:187], v196 offset:52224
    v_cvt_pk_bf16_f32 v84, v52, v53
    v_cvt_pk_bf16_f32 v85, v54, v55
    v_exp_f32 v56, v56
    v_exp_f32 v57, v57
    v_mfma_f32_32x32x16_bf16 v[116:131], v[172:175], v[92:95], v[116:131]
    ds_read_b128 v[156:159], v197 offset:0
    v_exp_f32 v58, v58
    v_exp_f32 v59, v59
    v_cvt_pk_bf16_f32 v86, v56, v57
    v_cvt_pk_bf16_f32 v87, v58, v59
    v_mfma_f32_16x16x32_bf16 v[152:155], v[188:191], v[92:95], v[152:155]
    v_exp_f32 v60, v60
    v_exp_f32 v61, v61
    v_mfma_f32_32x32x16_bf16 v[116:131], v[176:179], v[96:99], v[116:131]
    ds_read_b128 v[160:163], v197 offset:1024
    v_exp_f32 v62, v62
    v_exp_f32 v63, v63
    v_exp_f32_e64 v64, v64
    v_cvt_pk_bf16_f32 v88, v60, v61
    v_mfma_f32_16x16x32_bf16 v[152:155], v[188:191], v[96:99], v[152:155]
    v_exp_f32_e64 v65, v65
    v_cvt_pk_bf16_f32 v89, v62, v63
    v_exp_f32 v66, v66
    v_exp_f32 v67, v67
    v_cvt_pk_bf16_f32 v90, v64, v65
    v_cvt_pk_bf16_f32 v91, v66, v67
    s_waitcnt lgkmcnt(0)
    s_nop 0
    v_mfma_f32_32x32x16_bf16 v[52:67], v[156:159], v[4:7], v[20:35]
    v_exp_f32 v68, v68
    v_exp_f32 v69, v69
    v_exp_f32 v70, v70
    v_exp_f32 v71, v71
    v_mfma_f32_32x32x16_bf16 v[52:67], v[160:163], v[8:11], v[52:67]
    v_cvt_pk_bf16_f32 v92, v68, v69
    v_cvt_pk_bf16_f32 v93, v70, v71
    v_exp_f32 v72, v72
    v_exp_f32 v73, v73
    v_mfma_f32_32x32x16_bf16 v[100:115], v[180:183], v[84:87], v[100:115]
    v_exp_f32 v74, v74
    v_exp_f32 v75, v75
    v_cvt_pk_bf16_f32 v94, v72, v73
    v_cvt_pk_bf16_f32 v95, v74, v75
    v_mfma_f32_16x16x32_bf16 v[148:151], v[188:191], v[84:87], v[148:151]
    v_exp_f32 v76, v76
    v_exp_f32 v77, v77
    v_mfma_f32_32x32x16_bf16 v[100:115], v[184:187], v[88:91], v[100:115]
    v_exp_f32 v78, v78
    v_exp_f32 v79, v79
    v_exp_f32_e64 v80, v80
    v_cvt_pk_bf16_f32 v96, v76, v77
    v_mfma_f32_16x16x32_bf16 v[148:151], v[188:191], v[88:91], v[148:151]
    v_exp_f32_e64 v81, v81
    v_cvt_pk_bf16_f32 v97, v78, v79
    v_exp_f32 v82, v82
    v_exp_f32 v83, v83
    v_cvt_pk_bf16_f32 v98, v80, v81
    v_cvt_pk_bf16_f32 v99, v82, v83
    s_bitcmp1_b32 s44, 3
    s_cbranch_scc1 L_hookF3
L_retF3:
    s_barrier
    s_nop 0
    v_mfma_f32_32x32x16_bf16 v[68:83], v[156:159], v[12:15], v[36:51]
    ds_read_b128 v[172:175], v197 offset:2048
    v_exp_f32 v52, v52
    v_exp_f32 v53, v53
    v_exp_f32 v54, v54
    v_exp_f32 v55, v55
    v_mfma_f32_32x32x16_bf16 v[68:83], v[160:163], v[16:19], v[68:83]
    ds_read_b128 v[176:179], v197 offset:3072
    v_cvt_pk_bf16_f32 v84, v52, v53
    v_cvt_pk_bf16_f32 v85, v54, v55
    v_exp_f32 v56, v56
    v_exp_f32 v57, v57
    v_mfma_f32_32x32x16_bf16 v[116:131], v[180:183], v[92:95], v[116:131]
    ds_read_b128 v[164:167], v197 offset:16384
    v_exp_f32 v58, v58
    v_exp_f32 v59, v59
    v_cvt_pk_bf16_f32 v86, v56, v57
    v_cvt_pk_bf16_f32 v87, v58, v59
    v_mfma_f32_16x16x32_bf16 v[152:155], v[188:191], v[92:95], v[152:155]
    v_exp_f32 v60, v60
    v_exp_f32 v61, v61
    v_mfma_f32_32x32x16_bf16 v[116:131], v[184:187], v[96:99], v[116:131]
    ds_read_b128 v[168:171], v197 offset:17408
    v_exp_f32 v62, v62
    v_exp_f32 v63, v63
    v_exp_f32_e64 v64, v64
    v_cvt_pk_bf16_f32 v88, v60, v61
    v_mfma_f32_16x16x32_bf16 v[152:155], v[188:191], v[96:99], v[152:155]
    v_exp_f32_e64 v65, v65
    v_cvt_pk_bf16_f32 v89, v62, v63
    v_exp_f32 v66, v66
    v_exp_f32 v67, v67
    v_cvt_pk_bf16_f32 v90, v64, v65
    v_cvt_pk_bf16_f32 v91, v66, v67
    s_waitcnt lgkmcnt(0)
    s_nop 0
    v_mfma_f32_32x32x16_bf16 v[52:67], v[164:167], v[4:7], v[20:35]
    v_exp_f32 v68, v68
    v_exp_f32 v69, v69
    v_exp_f32 v70, v70
    v_exp_f32 v71, v71
    v_mfma_f32_32x32x16_bf16 v[52:67], v[168:171], v[8:11], v[52:67]
    v_cvt_pk_bf16_f32 v92, v68, v69
    v_cvt_pk_bf16_f32 v93, v70, v71
    v_exp_f32 v72, v72
    v_exp_f32 v73, v73
    v_mfma_f32_32x32x16_bf16 v[100:115], v[172:175], v[84:87], v[100:115]
    v_exp_f32 v74, v74
    v_exp_f32 v75, v75
    v_cvt_pk_bf16_f32 v94, v72, v73
    v_cvt_pk_bf16_f32 v95, v74, v75
    v_mfma_f32_16x16x32_bf16 v[148:151], v[188:191], v[84:87], v[148:151]
    v_exp_f32 v76, v76
    v_exp_f32 v77, v77
    v_mfma_f32_32x32x16_bf16 v[100:115], v[176:179], v[88:91], v[100:115]
    v_exp_f32 v78, v78
    v_exp_f32 v79, v79
    v_exp_f32_e64 v80, v80
    v_cvt_pk_bf16_f32 v96, v76, v77
    v_mfma_f32_16x16x32_bf16 v[148:151], v[188:191], v[88:91], v[148:151]
    v_exp_f32_e64 v81, v81
    v_cvt_pk_bf16_f32 v97, v78, v79
    v_exp_f32 v82, v82
    v_exp_f32 v83, v83
    v_cvt_pk_bf16_f32 v98, v80, v81
    v_cvt_pk_bf16_f32 v99, v82, v83
    s_barrier
    s_nop 0
    v_mfma_f32_32x32x16_bf16 v[68:83], v[164:167], v[12:15], v[36:51]
    ds_read_b128 v[180:183], v197 offset:18432
    v_exp_f32 v52, v52
    v_exp_f32 v53, v53
    v_exp_f32 v54, v54
    v_exp_f32 v55, v55
    v_mfma_f32_32x32x16_bf16 v[68:83], v[168:171], v[16:19], v[68:83]
    ds_read_b128 v[184:187], v197 offset:19456
    v_cvt_pk_bf16_f32 v84, v52, v53
    v_cvt_pk_bf16_f32 v85, v54, v55
    v_exp_f32 v56, v56
    v_exp_f32 v57, v57
    v_mfma_f32_32x32x16_bf16 v[116:131], v[172:175], v[92:95], v[116:131]
    ds_read_b128 v[156:159], v197 offset:32768
    v_exp_f32 v58, v58
    v_exp_f32 v59, v59
    v_cvt_pk_bf16_f32 v86, v56, v57
    v_cvt_pk_bf16_f32 v87, v58, v59
    v_mfma_f32_16x16x32_bf16 v[152:155], v[188:191], v[92:95], v[152:155]
    v_exp_f32 v60, v60
    v_exp_f32 v61, v61
    v_mfma_f32_32x32x16_bf16 v[116:131], v[176:179], v[96:99], v[116:131]
    ds_read_b128 v[160:163], v197 offset:33792
    v_exp_f32 v62, v62
    v_exp_f32 v63, v63
    v_exp_f32_e64 v64, v64
    v_cvt_pk_bf16_f32 v88, v60, v61
    v_mfma_f32_16x16x32_bf16 v[152:155], v[188:191], v[96:99], v[152:155]
    v_exp_f32_e64 v65, v65
    v_cvt_pk_bf16_f32 v89, v62, v63
    v_exp_f32 v66, v66
    v_exp_f32 v67, v67
    v_cvt_pk_bf16_f32 v90, v64, v65
    v_cvt_pk_bf16_f32 v91, v66, v67
    s_waitcnt lgkmcnt(0)
    s_nop 0
    v_mfma_f32_32x32x16_bf16 v[52:67], v[156:159], v[4:7], v[20:35]
    v_exp_f32 v68, v68
    v_exp_f32 v69, v69
    v_exp_f32 v70, v70
    v_exp_f32 v71, v71
    v_mfma_f32_32x32x16_bf16 v[52:67], v[160:163], v[8:11], v[52:67]
    v_cvt_pk_bf16_f32 v92, v68, v69
    v_cvt_pk_bf16_f32 v93, v70, v71
    v_exp_f32 v72, v72
    v_exp_f32 v73, v73
    v_mfma_f32_32x32x16_bf16 v[100:115], v[180:183], v[84:87], v[100:115]
    v_exp_f32 v74, v74
    v_exp_f32 v75, v75
    v_cvt_pk_bf16_f32 v94, v72, v73
    v_cvt_pk_bf16_f32 v95, v74, v75
    v_mfma_f32_16x16x32_bf16 v[148:151], v[188:191], v[84:87], v[148:151]
    v_exp_f32 v76, v76
    v_exp_f32 v77, v77
    v_mfma_f32_32x32x16_bf16 v[100:115], v[184:187], v[88:91], v[100:115]
    v_exp_f32 v78, v78
    v_exp_f32 v79, v79
    v_exp_f32_e64 v80, v80
    v_cvt_pk_bf16_f32 v96, v76, v77
    v_mfma_f32_16x16x32_bf16 v[148:151], v[188:191], v[88:91], v[148:151]
    v_exp_f32_e64 v81, v81
    v_cvt_pk_bf16_f32 v97, v78, v79
    v_exp_f32 v82, v82
    v_exp_f32 v83, v83
    v_cvt_pk_bf16_f32 v98, v80, v81
    v_cvt_pk_bf16_f32 v99, v82, v83
    s_bitcmp1_b32 s44, 5
    s_cbranch_scc1 L_hookF5
L_retF5:
    s_barrier
    s_nop 0
    v_mfma_f32_32x32x16_bf16 v[68:83], v[156:159], v[12:15], v[36:51]
    ds_read_b128 v[172:175], v197 offset:34816
    v_exp_f32 v52, v52
    v_exp_f32 v53, v53
    v_exp_f32 v54, v54
    v_exp_f32 v55, v55
    v_mfma_f32_32x32x16_bf16 v[68:83], v[160:163], v[16:19], v[68:83]
    ds_read_b128 v[176:179], v197 offset:35840
    v_cvt_pk_bf16_f32 v84, v52, v53
    v_cvt_pk_bf16_f32 v85, v54, v55
    v_exp_f32 v56, v56
    v_exp_f32 v57, v57
    v_mfma_f32_32x32x16_bf16 v[116:131], v[180:183], v[92:95], v[116:131]
    ds_read_b128 v[164:167], v197 offset:49152
    v_exp_f32 v58, v58
    v_exp_f32 v59, v59
    v_cvt_pk_bf16_f32 v86, v56, v57
    v_cvt_pk_bf16_f32 v87, v58, v59
    v_mfma_f32_16x16x32_bf16 v[152:155], v[188:191], v[92:95], v[152:155]
    v_exp_f32 v60, v60
    v_exp_f32 v61, v61
    v_mfma_f32_32x32x16_bf16 v[116:131], v[184:187], v[96:99], v[116:131]
    ds_read_b128 v[168:171], v197 offset:50176
    v_exp_f32 v62, v62
    v_exp_f32 v63, v63
    v_exp_f32_e64 v64, v64
    v_cvt_pk_bf16_f32 v88, v60, v61
    v_mfma_f32_16x16x32_bf16 v[152:155], v[188:191], v[96:99], v[152:155]
    v_exp_f32_e64 v65, v65
    v_cvt_pk_bf16_f32 v89, v62, v63
    v_exp_f32 v66, v66
    v_exp_f32 v67, v67
    v_cvt_pk_bf16_f32 v90, v64, v65
    v_cvt_pk_bf16_f32 v91, v66, v67
    s_waitcnt lgkmcnt(0)
    s_nop 0
    v_mfma_f32_32x32x16_bf16 v[52:67], v[164:167], v[4:7], v[20:35]
    v_exp_f32 v68, v68
    v_exp_f32 v69, v69
    v_exp_f32 v70, v70
    v_exp_f32 v71, v71
    v_mfma_f32_32x32x16_bf16 v[52:67], v[168:171], v[8:11], v[52:67]
    v_cvt_pk_bf16_f32 v92, v68, v69
    v_cvt_pk_bf16_f32 v93, v70, v71
    v_exp_f32 v72, v72
    v_exp_f32 v73, v73
    v_mfma_f32_32x32x16_bf16 v[100:115], v[172:175], v[84:87], v[100:115]
    v_exp_f32 v74, v74
    v_exp_f32 v75, v75
    v_cvt_pk_bf16_f32 v94, v72, v73
    v_cvt_pk_bf16_f32 v95, v74, v75
    v_mfma_f32_16x16x32_bf16 v[148:151], v[188:191], v[84:87], v[148:151]
    v_exp_f32 v76, v76
    v_exp_f32 v77, v77
    v_mfma_f32_32x32x16_bf16 v[100:115], v[176:179], v[88:91], v[100:115]
    v_exp_f32 v78, v78
    v_exp_f32 v79, v79
    v_exp_f32_e64 v80, v80
    v_cvt_pk_bf16_f32 v96, v76, v77
    v_mfma_f32_16x16x32_bf16 v[148:151], v[188:191], v[88:91], v[148:151]
    v_exp_f32_e64 v81, v81
    v_cvt_pk_bf16_f32 v97, v78, v79
    v_exp_f32 v82, v82
    v_exp_f32 v83, v83
    v_cvt_pk_bf16_f32 v98, v80, v81
    v_cvt_pk_bf16_f32 v99, v82, v83
    s_barrier
    s_nop 0
    v_mfma_f32_32x32x16_bf16 v[68:83], v[164:167], v[12:15], v[36:51]
    ds_read_b128 v[180:183], v197 offset:51200
    v_exp_f32 v52, v52
    v_exp_f32 v53, v53
    v_exp_f32 v54, v54
    v_exp_f32 v55, v55
    v_mfma_f32_32x32x16_bf16 v[68:83], v[168:171], v[16:19], v[68:83]
    ds_read_b128 v[184:187], v197 offset:52224
    v_cvt_pk_bf16_f32 v84, v52, v53
    v_cvt_pk_bf16_f32 v85, v54, v55
    v_exp_f32 v56, v56
    v_exp_f32 v57, v57
    v_mfma_f32_32x32x16_bf16 v[116:131], v[172:175], v[92:95], v[116:131]
    ds_read_b128 v[156:159], v196 offset:0
    v_exp_f32 v58, v58
    v_exp_f32 v59, v59
    v_cvt_pk_bf16_f32 v86, v56, v57
    v_cvt_pk_bf16_f32 v87, v58, v59
    v_mfma_f32_16x16x32_bf16 v[152:155], v[188:191], v[92:95], v[152:155]
    v_exp_f32 v60, v60
    v_exp_f32 v61, v61
    v_mfma_f32_32x32x16_bf16 v[116:131], v[176:179], v[96:99], v[116:131]
    ds_read_b128 v[160:163], v196 offset:1024
    v_exp_f32 v62, v62
    v_exp_f32 v63, v63
    v_exp_f32_e64 v64, v64
    v_cvt_pk_bf16_f32 v88, v60, v61
    v_mfma_f32_16x16x32_bf16 v[152:155], v[188:191], v[96:99], v[152:155]
    v_exp_f32_e64 v65, v65
    v_cvt_pk_bf16_f32 v89, v62, v63
    v_exp_f32 v66, v66
    v_exp_f32 v67, v67
    v_cvt_pk_bf16_f32 v90, v64, v65
    v_cvt_pk_bf16_f32 v91, v66, v67
    s_waitcnt lgkmcnt(0)
    s_nop 0
    v_mfma_f32_32x32x16_bf16 v[52:67], v[156:159], v[4:7], v[20:35]
    v_exp_f32 v68, v68
    v_exp_f32 v69, v69
    v_exp_f32 v70, v70
    v_exp_f32 v71, v71
    v_mfma_f32_32x32x16_bf16 v[52:67], v[160:163], v[8:11], v[52:67]
    v_cvt_pk_bf16_f32 v92, v68, v69
    v_cvt_pk_bf16_f32 v93, v70, v71
    v_exp_f32 v72, v72
    v_exp_f32 v73, v73
    v_mfma_f32_32x32x16_bf16 v[100:115], v[180:183], v[84:87], v[100:115]
    v_exp_f32 v74, v74
    v_exp_f32 v75, v75
    v_cvt_pk_bf16_f32 v94, v72, v73
    v_cvt_pk_bf16_f32 v95, v74, v75
    v_mfma_f32_16x16x32_bf16 v[148:151], v[188:191], v[84:87], v[148:151]
    v_exp_f32 v76, v76
    v_exp_f32 v77, v77
    v_mfma_f32_32x32x16_bf16 v[100:115], v[184:187], v[88:91], v[100:115]
    v_exp_f32 v78, v78
    v_exp_f32 v79, v79
    v_exp_f32_e64 v80, v80
    v_cvt_pk_bf16_f32 v96, v76, v77
    v_mfma_f32_16x16x32_bf16 v[148:151], v[188:191], v[88:91], v[148:151]
    v_exp_f32_e64 v81, v81
    v_cvt_pk_bf16_f32 v97, v78, v79
    v_exp_f32 v82, v82
    v_exp_f32 v83, v83
    v_cvt_pk_bf16_f32 v98, v80, v81
    v_cvt_pk_bf16_f32 v99, v82, v83
    s_lshr_b32 s44, s44, 8
    s_add_u32 s35, s35, 1
    s_cmp_lt_u32 s35, 4
    s_cbranch_scc1 L_mainF
    v_mfma_f32_32x32x16_bf16 v[116:131], v[180:183], v[92:95], v[116:131]
    v_mfma_f32_16x16x32_bf16 v[152:155], v[188:191], v[92:95], v[152:155]
    v_mfma_f32_32x32x16_bf16 v[116:131], v[184:187], v[96:99], v[116:131]
    v_mfma_f32_16x16x32_bf16 v[152:155], v[188:191], v[96:99], v[152:155]
    s_branch L_attn_end
L_hookF5:
    s_and_b32 s48, s28, 3
    s_lshl_b32 s48, s48, 2
    s_add_u32 s48, s48, s59
    s_add_u32 s48, s48, 16
    s_waitcnt vmcnt(0)
    v_mov_b32 v192, 0
    v_mov_b32 v193, s58
    v_cmp_eq_u32 vcc, 0, v1
    s_and_saveexec_b64 s[50:51], vcc
    buffer_store_dword v193, v192, s[20:23], s48 offen sc1
    s_mov_b64 exec, s[50:51]
    s_cmp_lg_u32 s28, 5
    s_cbranch_scc1 L_retF5
    s_lshl_b32 s48, s2, 13
    v_lshlrev_b32_e64 v192, 7, v1
    s_mov_b32 s8, s82
    s_mov_b32 s9, s83
    s_mov_b32 s10, 0x200000
    s_mov_b32 s11, 0x20000
    buffer_load_dword v223, v192, s[8:11], s48 offen
    s_mov_b32 s8, s84
    s_mov_b32 s9, s85
    s_mov_b32 s10, 0x200000
    s_mov_b32 s11, 0x20000
    buffer_load_dword v224, v192, s[8:11], s48 offen
    s_branch L_retF5
L_hookF0:
    s_lshl_b32 s48, s32, 12
    s_add_u32 s48, s48, 131072
    v_add_u32 v192, s48, v2
    s_lshl_b32 s48, s32, 7
    s_add_u32 s48, s48, 139264
    v_lshrrev_b32 v193, 5, v1
    v_lshlrev_b32 v193, 5, v193
    v_add_u32_e64 v193, s48, v193
    v_mov_b32 v194, 140032
    v_cmp_ne_u32 vcc, 0, v188
    s_lshl_b32 s48, s47, 7
    s_add_u32 s48, s48, 139520
    v_cndmask_b32 v193, v194, v193, vcc
    s_nop 0
    ds_read_b128 v[240:243], v193 offset:0
    ds_read_b128 v[244:247], v193 offset:16
    ds_read_b128 v[248:251], v193 offset:64
    ds_read_b128 v[252:255], v193 offset:80
    ds_read_b128 v[200:203], v192 offset:0
    ds_read_b128 v[204:207], v192 offset:1024
    ds_read_b128 v[208:211], v192 offset:2048
    ds_read_b128 v[212:215], v192 offset:3072
    v_and_b32 v194, 31, v1
    v_lshlrev_b32 v194, 2, v194
    v_add_u32_e64 v194, s48, v194
    ds_read_b32 v198, v194
    s_lshl_b32 s49, s46, 17
    s_lshl_b32 s48, s34, 11
    s_add_u32 s49, s49, s48
    s_nop 0
    s_add_u32 s49, s49, 33619968
    s_waitcnt lgkmcnt(5)
    s_nop 0
    v_mfma_f32_16x16x32_bf16 v[216:219], v[240:243], v[132:135], 0
    v_mfma_f32_16x16x32_bf16 v[216:219], v[244:247], v[136:139], v[216:219]
    v_mfma_f32_16x16x32_bf16 v[216:219], v[248:251], v[140:143], v[216:219]
    v_mfma_f32_16x16x32_bf16 v[216:219], v[252:255], v[144:147], v[216:219]
    s_waitcnt lgkmcnt(0)
    s_nop 0
    v_mfma_f32_32x32x16_bf16 v[240:255], v[200:203], v[132:135], 0
    v_mfma_f32_32x32x16_bf16 v[240:255], v[204:207], v[136:139], v[240:255]
    v_mfma_f32_32x32x16_bf16 v[240:255], v[208:211], v[140:143], v[240:255]
    v_mfma_f32_32x32x16_bf16 v[240:255], v[212:215], v[144:147], v[240:255]
    v_sub_f32 v193, 1.0, v198
    s_nop 1
    v_add_f32 v192, 0x358637bd, v216
    v_rcp_f32 v192, v192
    s_nop 0
    v_mul_f32 v192, v192, v193
    s_nop 4
    v_mul_f32 v240, v240, v192
    v_mul_f32 v241, v241, v192
    v_cvt_pk_bf16_f32 v200, v240, v241
    v_mul_f32 v242, v242, v192
    v_mul_f32 v243, v243, v192
    v_cvt_pk_bf16_f32 v201, v242, v243
    v_mul_f32 v244, v244, v192
    v_mul_f32 v245, v245, v192
    v_cvt_pk_bf16_f32 v202, v244, v245
    v_mul_f32 v246, v246, v192
    v_mul_f32 v247, v247, v192
    v_cvt_pk_bf16_f32 v203, v246, v247
    v_mul_f32 v248, v248, v192
    v_mul_f32 v249, v249, v192
    v_cvt_pk_bf16_f32 v204, v248, v249
    v_mul_f32 v250, v250, v192
    v_mul_f32 v251, v251, v192
    v_cvt_pk_bf16_f32 v205, v250, v251
    v_mul_f32 v252, v252, v192
    v_mul_f32 v253, v253, v192
    v_cvt_pk_bf16_f32 v206, v252, v253
    v_mul_f32 v254, v254, v192
    v_mul_f32 v255, v255, v192
    v_cvt_pk_bf16_f32 v207, v254, v255
    buffer_store_dwordx4 v[200:203], v2, s[20:23], s49 offen sc1
    buffer_store_dwordx4 v[204:207], v2, s[20:23], s49 offen offset:1024 sc1
    s_branch L_retF0
L_hookF3:
    s_lshl_b32 s48, s28, 2
    s_add_u32 s48, s48, s59
    s_nop 0
    s_add_u32 s48, s48, 80
    s_waitcnt vmcnt(0)
    v_mov_b32 v192, 0
    v_mov_b32_e64 v193, s58
    v_cmp_eq_u32 vcc, 0, v1
    s_and_saveexec_b64 s[50:51], vcc
    buffer_store_dword v193, v192, s[20:23], s48 offen sc1
    s_mov_b64 exec, s[50:51]
    s_branch L_retF3
L_hookL0:
    s_cmp_eq_u32 s35, 0
    s_cbranch_scc1 L_h0
    s_cmp_eq_u32 s35, 1
    s_cbranch_scc1 L_h8
    s_cmp_eq_u32 s35, 2
    s_cbranch_scc1 L_h16
    s_lshl_b32 s48, s32, 12
    s_nop 0
    s_add_u32 s48, s48, 131072
    v_add_u32 v192, s48, v2
    s_lshl_b32 s48, s32, 7
    s_add_u32 s48, s48, 139264
    v_lshrrev_b32 v193, 5, v1
    v_lshlrev_b32 v193, 5, v193
    v_add_u32_e64 v193, s48, v193
    v_mov_b32 v194, 140032
    v_cmp_ne_u32 vcc, 0, v188
    s_lshl_b32 s48, s47, 7
    s_add_u32 s48, s48, 139520
    v_cndmask_b32 v193, v194, v193, vcc
    s_nop 0
    ds_read_b128 v[240:243], v193 offset:0
    ds_read_b128 v[244:247], v193 offset:16
    ds_read_b128 v[248:251], v193 offset:64
    ds_read_b128 v[252:255], v193 offset:80
    ds_read_b128 v[200:203], v192 offset:0
    ds_read_b128 v[204:207], v192 offset:1024
    ds_read_b128 v[208:211], v192 offset:2048
    ds_read_b128 v[212:215], v192 offset:3072
    v_and_b32 v194, 31, v1
    v_lshlrev_b32 v194, 2, v194
    v_add_u32_e64 v194, s48, v194
    ds_read_b32 v198, v194
    s_lshl_b32 s49, s46, 17
    s_lshl_b32 s48, s34, 11
    s_add_u32 s49, s49, s48
    s_nop 0
    s_add_u32 s49, s49, 33619968
    s_waitcnt lgkmcnt(5)
    s_nop 0
    v_mfma_f32_16x16x32_bf16 v[216:219], v[240:243], v[132:135], 0
    v_mfma_f32_16x16x32_bf16 v[216:219], v[244:247], v[136:139], v[216:219]
    v_mfma_f32_16x16x32_bf16 v[216:219], v[248:251], v[140:143], v[216:219]
    v_mfma_f32_16x16x32_bf16 v[216:219], v[252:255], v[144:147], v[216:219]
    s_waitcnt lgkmcnt(0)
    s_nop 0
    v_mfma_f32_32x32x16_bf16 v[240:255], v[200:203], v[132:135], 0
    v_mfma_f32_32x32x16_bf16 v[240:255], v[204:207], v[136:139], v[240:255]
    v_mfma_f32_32x32x16_bf16 v[240:255], v[208:211], v[140:143], v[240:255]
    v_mfma_f32_32x32x16_bf16 v[240:255], v[212:215], v[144:147], v[240:255]
    v_sub_f32 v193, 1.0, v198
    s_nop 1
    v_add_f32 v192, 0x358637bd, v216
    v_rcp_f32 v192, v192
    s_nop 0
    v_mul_f32 v192, v192, v193
    s_nop 4
    v_mul_f32 v240, v240, v192
    v_mul_f32 v241, v241, v192
    v_cvt_pk_bf16_f32 v200, v240, v241
    v_mul_f32 v242, v242, v192
    v_mul_f32 v243, v243, v192
    v_cvt_pk_bf16_f32 v201, v242, v243
    v_mul_f32 v244, v244, v192
    v_mul_f32 v245, v245, v192
    v_cvt_pk_bf16_f32 v202, v244, v245
    v_mul_f32 v246, v246, v192
    v_mul_f32 v247, v247, v192
    v_cvt_pk_bf16_f32 v203, v246, v247
    v_mul_f32 v248, v248, v192
    v_mul_f32 v249, v249, v192
    v_cvt_pk_bf16_f32 v204, v248, v249
    v_mul_f32 v250, v250, v192
    v_mul_f32 v251, v251, v192
    v_cvt_pk_bf16_f32 v205, v250, v251
    v_mul_f32 v252, v252, v192
    v_mul_f32 v253, v253, v192
    v_cvt_pk_bf16_f32 v206, v252, v253
    v_mul_f32 v254, v254, v192
    v_mul_f32 v255, v255, v192
    v_cvt_pk_bf16_f32 v207, v254, v255
    buffer_store_dwordx4 v[200:203], v2, s[20:23], s49 offen sc1
    buffer_store_dwordx4 v[204:207], v2, s[20:23], s49 offen offset:1024 sc1
    s_branch L_retL0
L_hookL1:
    s_cmp_eq_u32 s35, 2
    s_cbranch_scc1 L_h17
    s_branch L_h25
L_hookL3:
    s_cmp_eq_u32 s35, 2
    s_cbranch_scc1 L_h19
    s_lshl_b32 s48, s28, 2
    s_add_u32 s48, s48, s59
    s_add_u32 s48, s48, 80
    s_waitcnt vmcnt(12)
    v_mov_b32 v192, 0
    v_mov_b32_e64 v193, s58
    v_cmp_eq_u32 vcc, 0, v1
    s_and_saveexec_b64 s[50:51], vcc
    buffer_store_dword v193, v192, s[20:23], s48 offen sc1
    s_mov_b64 exec, s[50:51]
    s_branch L_retL3
L_hookL5:
    s_cmp_eq_u32 s35, 1
    s_cbranch_scc1 L_h13
    s_branch L_h21
L_hookL6:
    s_cmp_eq_u32 s35, 1
    s_cbranch_scc1 L_h14
    s_branch L_h30
L_h0:
    s_mov_b32 m0, s78
    s_nop 0
    buffer_load_dwordx4 v220, s[24:27], s39 offen  lds
    buffer_load_dwordx4 v221, s[24:27], s39 offen offset:1024  lds
    s_add_u32 m0, m0, 8192
    s_nop 0
    s_nop 0
    buffer_load_dwordx4 v220, s[4:7], s39 offen  lds
    buffer_load_dwordx4 v221, s[4:7], s39 offen offset:1024  lds
    s_add_u32 s39, s39, s36
    s_and_b32 s39, s39, s37
    s_branch L_retL0
L_h8:
    s_lshl_b32 s48, s29, 11
    s_add_u32 s48, s48, 29360144
    buffer_load_dword v222, v232, s[20:23], s48 offen sc1
    s_branch L_retL0
L_hookL2:
    s_waitcnt vmcnt(8)
    s_lshl_b32 s48, s29, 11
    s_nop 0
    s_add_u32 s48, s48, 29360144
    s_mov_b32 s53, 0
    s_branch L_sp_p_3c
L_sp_p_3:
    s_sleep 2
    s_nop 0
    buffer_load_dword v222, v232, s[20:23], s48 offen sc1
    s_waitcnt vmcnt(0)
L_sp_p_3c:
    v_cmp_eq_u32 vcc, s58, v222
    s_add_u32 s53, s53, 1
    s_and_b32 s50, vcc_lo, 0xffffffff
    s_and_b32 s51, vcc_hi, 0xffffffff
    s_and_b32 s50, s50, s51
    s_cmp_eq_u32 s50, -1
    s_cbranch_scc1 L_ok_p_4
    s_cmp_lt_u32 s53, 400000
    s_cbranch_scc1 L_sp_p_3
L_ok_p_4:
    s_lshl_b32 s48, s28, 15
    s_lshr_b32 s49, s30, 1
    s_lshl_b32 s49, s49, 10
    s_add_u32 s48, s48, s49
    s_nop 0
    s_add_u32 s48, s48, 20971520
    buffer_load_dwordx4 v[200:203], v234, s[20:23], s48 offen sc1
    s_add_u32 s48, s48, 8192
    buffer_load_dwordx4 v[204:207], v234, s[20:23], s48 offen sc1
    s_add_u32 s48, s48, 8192
    buffer_load_dwordx4 v[208:211], v234, s[20:23], s48 offen sc1
    s_add_u32 s48, s48, 8192
    buffer_load_dwordx4 v[212:215], v234, s[20:23], s48 offen sc1
    s_cmp_lg_u32 s28, 1
    s_cbranch_scc1 L_retL2
    s_lshl_b32 s48, s30, 4
    s_nop 0
    s_add_u32 s48, s48, 25165824
    buffer_load_dwordx4 v[216:219], v236, s[20:23], s48 offen sc1
    s_branch L_retL2
L_h13:
    s_waitcnt vmcnt(12)
    v_pk_add_f32 v[200:201], v[200:201], v[204:205]
    v_pk_add_f32 v[202:203], v[202:203], v[206:207]
    v_pk_add_f32 v[208:209], v[208:209], v[212:213]
    v_pk_add_f32 v[210:211], v[210:211], v[214:215]
    s_lshl_b32 s48, s28, 10
    s_nop 0
    s_add_u32 s48, s48, 141312
    v_add_u32_e64 v192, s48, v2
    v_pk_add_f32 v[200:201], v[200:201], v[208:209]
    v_pk_add_f32 v[202:203], v[202:203], v[210:211]
    ds_write_b128 v192, v[200:203]
    s_cmp_lg_u32 s28, 1
    s_cbranch_scc1 L_h13x
    v_add_f32_dpp v216, v216, v216 row_ror:1 row_mask:0xf bank_mask:0xf
    v_add_f32_dpp v217, v217, v217 row_ror:1 row_mask:0xf bank_mask:0xf
    v_add_f32_dpp v218, v218, v218 row_ror:1 row_mask:0xf bank_mask:0xf
    v_add_f32_dpp v219, v219, v219 row_ror:1 row_mask:0xf bank_mask:0xf
    v_add_f32_dpp v216, v216, v216 row_ror:2 row_mask:0xf bank_mask:0xf
    v_add_f32_dpp v217, v217, v217 row_ror:2 row_mask:0xf bank_mask:0xf
    v_add_f32_dpp v218, v218, v218 row_ror:2 row_mask:0xf bank_mask:0xf
    v_add_f32_dpp v219, v219, v219 row_ror:2 row_mask:0xf bank_mask:0xf
    v_add_f32_dpp v216, v216, v216 row_ror:4 row_mask:0xf bank_mask:0xf
    v_add_f32_dpp v217, v217, v217 row_ror:4 row_mask:0xf bank_mask:0xf
    v_add_f32_dpp v218, v218, v218 row_ror:4 row_mask:0xf bank_mask:0xf
    v_add_f32_dpp v219, v219, v219 row_ror:4 row_mask:0xf bank_mask:0xf
    v_add_f32_dpp v216, v216, v216 row_ror:8 row_mask:0xf bank_mask:0xf
    v_add_f32_dpp v217, v217, v217 row_ror:8 row_mask:0xf bank_mask:0xf
    v_add_f32_dpp v218, v218, v218 row_ror:8 row_mask:0xf bank_mask:0xf
    v_add_f32_dpp v219, v219, v219 row_ror:8 row_mask:0xf bank_mask:0xf
    v_cvt_pk_bf16_f32 v216, v216, v217
    v_cvt_pk_bf16_f32 v217, v218, v219
    s_lshl_b32 s48, s30, 3
    s_nop 0
    s_add_u32 s48, s48, 28311552
    v_and_b32_e64 v194, 47, v1
    v_cmp_eq_u32 vcc, 0, v194
    s_and_saveexec_b64 s[50:51], vcc
    buffer_store_dwordx2 v[216:217], v237, s[20:23], s48 offen sc1
    s_mov_b64 exec, s[50:51]
L_h13x:
    s_waitcnt lgkmcnt(0)
    s_branch L_retL5
L_h14:
    s_nop 0
    v_add_u32 v192, 141312, v2
    ds_read_b128 v[200:203], v192 offset:0
    ds_read_b128 v[204:207], v192 offset:1024
    ds_read_b128 v[208:211], v192 offset:2048
    ds_read_b128 v[212:215], v192 offset:3072
    s_lshr_b32 s48, s30, 2
    s_lshl_b32 s48, s48, 10
    s_bfe_u32 s49, s30, 0x10001
    s_lshl_b32 s49, s49, 3
    s_add_u32 s48, s48, s49
    s_add_u32 s48, s48, 27262976
    s_waitcnt lgkmcnt(0)
    s_nop 0
    v_pk_add_f32 v[200:201], v[200:201], v[204:205]
    v_pk_add_f32 v[202:203], v[202:203], v[206:207]
    v_pk_add_f32 v[208:209], v[208:209], v[212:213]
    v_pk_add_f32 v[210:211], v[210:211], v[214:215]
    v_pk_add_f32 v[200:201], v[200:201], v[208:209]
    v_pk_add_f32 v[202:203], v[202:203], v[210:211]
    v_cvt_pk_bf16_f32 v200, v200, v201
    v_cvt_pk_bf16_f32 v201, v202, v203
    buffer_store_dwordx2 v[200:201], v235, s[20:23], s48 offen sc1
    s_branch L_retL6
L_h16:
    s_waitcnt vmcnt(12)
    s_branch L_retL0
L_h17:
    s_waitcnt vmcnt(12)
    s_add_u32 s48, s59, 68
    v_mov_b32 v192, 0
    v_mov_b32 v193, s58
    v_cmp_eq_u32 vcc, 0, v1
    s_and_saveexec_b64 s[50:51], vcc
    buffer_store_dword v193, v192, s[20:23], s48 offen sc1
    s_mov_b64 exec, s[50:51]
    s_branch L_retL1
L_h19:
    buffer_load_dword v222, v233, s[20:23], 0 offen sc1
    s_branch L_retL3
L_h21:
    s_waitcnt vmcnt(8)
    s_mov_b32 s53, 0
    s_branch L_sp_s_5c
L_sp_s_5:
    s_sleep 2
    s_nop 0
    buffer_load_dword v222, v233, s[20:23], 0 offen sc1
    s_waitcnt vmcnt(0)
L_sp_s_5c:
    v_cmp_eq_u32 vcc, s58, v222
    s_add_u32 s53, s53, 1
    s_and_b32 s50, vcc_lo, 0xffffffff
    s_cmp_eq_u32 s50, 0xffffffff
    s_cbranch_scc1 L_ok_s_6
    s_cmp_lt_u32 s53, 400000
    s_cbranch_scc1 L_sp_s_5
L_ok_s_6:
    s_lshl_b32 s48, s29, 13
    s_lshl_b32 s49, s28, 11
    s_add_u32 s48, s48, s49
    s_add_u32 s48, s48, 27262976
    s_add_u32 m0, s49, 131072
    s_nop 0
    s_nop 0
    buffer_load_dwordx4 v2, s[20:23], s48 offen sc1 lds
    buffer_load_dwordx4 v2, s[20:23], s48 offen offset:1024 sc1 lds
    s_cmp_lt_u32 s28, 2
    s_cbranch_scc1 L_retL5
    v_lshlrev_b32_e64 v192, 2, v1
    v_add_u32 v192, 140032, v192
    v_mov_b32 v193, 0
    s_mov_b64 s[50:51], exec
    s_mov_b32 exec_lo, -1
    s_mov_b32 exec_hi, 0
    ds_write_b32 v192, v193
    s_mov_b64 exec, s[50:51]
    s_lshl_b32 s48, s29, 8
    s_add_u32 s48, s48, 28311552
    s_lshl_b32 s49, s30, 9
    s_nop 0
    s_add_u32 s49, s49, 26214400
    s_cmp_eq_u32 s28, 2
    s_cselect_b32 s48, s48, s49
    s_cselect_b32 s49, 16, 32
    s_nop 0
    s_mov_b32 s52, 139520
    s_cselect_b32 m0, 139264, s52
    v_cmp_gt_u32 vcc, s49, v1
    s_and_saveexec_b64 s[50:51], vcc
    buffer_load_dwordx4 v2, s[20:23], s48 offen sc1 lds
    s_mov_b64 exec, s[50:51]
    s_branch L_retL5
L_hookL7:
    s_waitcnt vmcnt(8)
    s_branch L_retL7
L_h25:
    v_mov_b32 v220, v238
    v_mov_b32 v221, v239
    s_mov_b32 s24, s84
    s_mov_b32 s25, s85
    s_mov_b32 s26, 0x200000
    s_mov_b32 s27, 0x20000
    s_add_u32 s4, s84, 131072
    s_addc_u32 s5, s85, 0
    s_nop 0
    s_mov_b32 s6, 1966080
    s_mov_b32 s7, 0x20000
    s_mov_b32 s39, 0
    s_nop 0
    s_mov_b32 s36, 262144
    s_mov_b32 s37, -1
    s_branch L_retL1
L_h30:
    s_and_b32 s48, s2, 7
    s_lshr_b32 s48, s48, 1
    s_lshl_b32 s48, s48, 2
    s_nop 0
    s_bfe_u32 s49, s2, 0x20003
    s_add_u32 s48, s48, s49
    s_lshl_b32 s48, s48, 7
    s_add_u32 s56, s48, 29360208
    v_lshrrev_b32 v192, 2, v1
    v_lshlrev_b32 v192, 11, v192
    v_and_b32_e64 v193, 3, v1
    v_lshl_add_u32 v225, v193, 3, v192
    buffer_load_dwordx2 v[228:229], v225, s[20:23], s56 offen sc1
    s_branch L_retL6
L_attn_end:
    s_and_b32 s48, s28, 3
    s_lshl_b32 s48, s48, 12
    s_nop 0
    s_mov_b32 s49, 141312
    s_cmp_lt_u32 s28, 4
    s_nop 0
    s_cselect_b32 s52, 114688, s49
    s_cselect_b32 s53, s49, 114688
    s_add_u32 s52, s52, s48
    s_add_u32 s53, s53, s48
    v_add_u32 v192, s52, v2
    s_lshl_b32 s48, s28, 8
    s_add_u32 s49, s48, 157696
    v_lshlrev_b32 v194, 2, v1
    v_add_u32 v193, s49, v194
    s_xor_b32 s48, s48, 1024
    s_add_u32 s48, s48, 157696
    v_add_u32 v194, s48, v194
    s_cmp_lg_u32 s28, 0
    s_cbranch_scc1 L_s4_done
    s_and_b32 s48, s2, 7
    s_lshr_b32 s48, s48, 1
    s_lshl_b32 s48, s48, 2
    s_bfe_u32 s49, s2, 0x20003
    s_add_u32 s48, s48, s49
    s_lshl_b32 s48, s48, 7
    s_add_u32 s56, s48, 29360208
    v_lshrrev_b32 v226, 2, v1
    v_lshlrev_b32 v226, 11, v226
    v_and_b32_e64 v225, 3, v1
    v_lshl_add_u32 v225, v225, 3, v226
    s_mov_b32 s57, 0
    s_waitcnt vmcnt(8)
    s_branch L_s4_first
L_s4_spin:
    s_sleep 2
    buffer_load_dwordx2 v[228:229], v225, s[20:23], s56 offen sc1
    s_waitcnt vmcnt(0)
L_s4_first:
    s_add_u32 s57, s57, 1
    v_cmp_eq_u32 vcc, s58, v228
    s_nop 0
    v_cmp_eq_u32 s[50:51], s58, v229
    s_and_b64 vcc, vcc, s[50:51]
    s_cmp_eq_u64 vcc, -1
    s_cbranch_scc1 L_s4_done
    s_nop 0
    s_cmp_lt_u32 s57, 400000
    s_cbranch_scc1 L_s4_spin
L_s4_done:
    s_barrier
    ds_write_b128 v192, v[116:119] offset:0
    ds_write_b128 v192, v[120:123] offset:1024
    ds_write_b128 v192, v[124:127] offset:2048
    ds_write_b128 v192, v[128:131] offset:3072
    ds_write_b32 v193, v152
    v_add_u32_e64 v192, s53, v2
    s_waitcnt lgkmcnt(0)
    s_barrier
    ds_read_b128 v[52:55], v192 offset:0
    ds_read_b128 v[56:59], v192 offset:1024
    ds_read_b128 v[60:63], v192 offset:2048
    ds_read_b128 v[64:67], v192 offset:3072
    ds_read_b32 v152, v194
    s_waitcnt lgkmcnt(0)
    s_nop 0
    v_pk_add_f32 v[100:101], v[100:101], v[52:53]
    v_pk_add_f32 v[102:103], v[102:103], v[54:55]
    v_pk_add_f32 v[104:105], v[104:105], v[56:57]
    v_pk_add_f32 v[106:107], v[106:107], v[58:59]
    v_pk_add_f32 v[108:109], v[108:109], v[60:61]
    v_pk_add_f32 v[110:111], v[110:111], v[62:63]
    v_pk_add_f32 v[112:113], v[112:113], v[64:65]
    v_pk_add_f32 v[114:115], v[114:115], v[66:67]
    v_add_f32 v148, v148, v152
    v_mov_b32 v192, 0
    v_fma_f32 v192, v100, 0, v192
    v_fma_f32 v192, v101, 0, v192
    v_fma_f32 v192, v102, 0, v192
    v_fma_f32 v192, v103, 0, v192
    v_fma_f32 v192, v104, 0, v192
    v_fma_f32 v192, v105, 0, v192
    v_fma_f32 v192, v106, 0, v192
    v_fma_f32 v192, v107, 0, v192
    v_fma_f32 v192, v108, 0, v192
    v_fma_f32 v192, v109, 0, v192
    v_fma_f32 v192, v110, 0, v192
    v_fma_f32 v192, v111, 0, v192
    v_fma_f32 v192, v112, 0, v192
    v_fma_f32 v192, v113, 0, v192
    v_fma_f32 v192, v114, 0, v192
    v_fma_f32 v192, v115, 0, v192
    v_mov_b32 v193, 0x7b800000
    v_cmp_nlt_f32 vcc, v148, v193
    s_nop 0
    v_cmp_neq_f32 s[50:51], 0, v192
    s_or_b64 vcc, vcc, s[50:51]
    s_nop 0
    v_mov_b32 v193, 0xd800000
    v_cmp_ngt_f32 s[54:55], v148, v193
    s_or_b64 s[54:55], vcc, s[54:55]
    s_cmp_eq_u64 s[54:55], 0
    s_cbranch_scc1 L_okmax
    s_lshl_b32 s44, s34, 18
    s_add_u32 s44, s44, 4194304
    v_mov_b32 v194, 0xff800000
    s_mov_b32 s45, 0
L_fb1:
    s_lshl_b32 s49, s45, 12
    s_add_u32 s49, s49, s44
    s_nop 0
    buffer_load_dwordx4 v[156:159], v2, s[20:23], s49 offen offset:0
    buffer_load_dwordx4 v[160:163], v2, s[20:23], s49 offen offset:1024
    s_waitcnt vmcnt(0)
    s_nop 0
    v_mfma_f32_32x32x16_bf16 v[52:67], v[156:159], v[4:7], 0
    v_mfma_f32_32x32x16_bf16 v[52:67], v[160:163], v[8:11], v[52:67]
    s_nop 11
    s_nop 0
    v_max3_f32 v194, v194, v52, v53
    v_max3_f32 v194, v194, v54, v55
    v_max3_f32 v194, v194, v56, v57
    v_max3_f32 v194, v194, v58, v59
    v_max3_f32 v194, v194, v60, v61
    v_max3_f32 v194, v194, v62, v63
    v_max3_f32 v194, v194, v64, v65
    v_max3_f32 v194, v194, v66, v67
    s_add_u32 s45, s45, 1
    s_cmp_lt_u32 s45, 64
    s_cbranch_scc1 L_fb1
    v_mov_b32 v193, v194
    s_nop 1
    v_permlane32_swap_b32 v194, v193
    v_max_f32 v192, v194, v193
    v_sub_f32 v20, 0, v192
    v_mov_b32 v100, 0
    v_sub_f32 v21, 0, v192
    v_mov_b32 v101, 0
    v_sub_f32 v22, 0, v192
    v_mov_b32 v102, 0
    v_sub_f32 v23, 0, v192
    v_mov_b32 v103, 0
    v_sub_f32 v24, 0, v192
    v_mov_b32 v104, 0
    v_sub_f32 v25, 0, v192
    v_mov_b32 v105, 0
    v_sub_f32 v26, 0, v192
    v_mov_b32 v106, 0
    v_sub_f32 v27, 0, v192
    v_mov_b32 v107, 0
    v_sub_f32 v28, 0, v192
    v_mov_b32 v108, 0
    v_sub_f32 v29, 0, v192
    v_mov_b32 v109, 0
    v_sub_f32 v30, 0, v192
    v_mov_b32 v110, 0
    v_sub_f32 v31, 0, v192
    v_mov_b32 v111, 0
    v_sub_f32 v32, 0, v192
    v_mov_b32 v112, 0
    v_sub_f32 v33, 0, v192
    v_mov_b32 v113, 0
    v_sub_f32 v34, 0, v192
    v_mov_b32 v114, 0
    v_sub_f32 v35, 0, v192
    v_mov_b32 v115, 0
    v_mov_b32 v148, 0
    v_mov_b32 v149, 0
    v_mov_b32 v150, 0
    v_mov_b32 v151, 0
    s_mov_b32 s45, 0
L_fb2:
    s_lshl_b32 s49, s45, 12
    s_add_u32 s49, s49, s44
    buffer_load_dwordx4 v[156:159], v2, s[20:23], s49 offen offset:0
    buffer_load_dwordx4 v[160:163], v2, s[20:23], s49 offen offset:1024
    buffer_load_dwordx4 v[172:175], v2, s[20:23], s49 offen offset:2048
    buffer_load_dwordx4 v[176:179], v2, s[20:23], s49 offen offset:3072
    s_waitcnt vmcnt(0)
    s_nop 0
    v_mfma_f32_32x32x16_bf16 v[52:67], v[156:159], v[4:7], v[20:35]
    v_mfma_f32_32x32x16_bf16 v[52:67], v[160:163], v[8:11], v[52:67]
    s_nop 11
    v_exp_f32 v52, v52
    v_exp_f32 v53, v53
    v_exp_f32 v54, v54
    v_exp_f32 v55, v55
    v_exp_f32 v56, v56
    v_exp_f32 v57, v57
    v_exp_f32 v58, v58
    v_exp_f32 v59, v59
    v_exp_f32 v60, v60
    v_exp_f32 v61, v61
    v_exp_f32 v62, v62
    v_exp_f32 v63, v63
    v_exp_f32 v64, v64
    v_exp_f32 v65, v65
    v_exp_f32 v66, v66
    v_exp_f32_e64 v67, v67
    v_cvt_pk_bf16_f32 v84, v52, v53
    v_cvt_pk_bf16_f32 v85, v54, v55
    v_cvt_pk_bf16_f32 v86, v56, v57
    v_cvt_pk_bf16_f32 v87, v58, v59
    v_cvt_pk_bf16_f32 v88, v60, v61
    v_cvt_pk_bf16_f32 v89, v62, v63
    v_cvt_pk_bf16_f32 v90, v64, v65
    v_cvt_pk_bf16_f32 v91, v66, v67
    v_mfma_f32_32x32x16_bf16 v[100:115], v[172:175], v[84:87], v[100:115]
    s_nop 0
    s_nop 0
    v_mfma_f32_32x32x16_bf16 v[100:115], v[176:179], v[88:91], v[100:115]
    v_mfma_f32_16x16x32_bf16 v[148:151], v[188:191], v[84:87], v[148:151]
    v_mfma_f32_16x16x32_bf16 v[148:151], v[188:191], v[88:91], v[148:151]
    s_add_u32 s45, s45, 1
    s_cmp_lt_u32 s45, 64
    s_cbranch_scc1 L_fb2
L_okmax:
    s_and_b32 s33, s2, 7
    s_lshr_b32 s48, s2, 3
    s_lshr_b32 s29, s33, 1
    s_lshl_b32 s29, s29, 2
    s_and_b32 s49, s48, 3
    s_add_u32 s29, s29, s49
    s_and_b32 s30, s33, 1
    s_lshl_b32 s30, s30, 3
    s_lshr_b32 s49, s48, 2
    s_add_u32 s30, s30, s49
    s_and_b32 s31, s28, 3
    s_lshr_b32 s32, s28, 2
    s_lshl_b32 s48, s29, 2
    s_add_u32 s48, s48, s31
    s_lshl_b32 s35, s48, 17
    s_lshl_b32 s49, s32, 12
    s_add_u32 s35, s35, s49
    s_add_u32 s35, s35, 33554432
    s_lshl_b32 s47, s46, 17
    s_lshl_b32 s48, s34, 11
    s_add_u32 s47, s47, s48
    s_nop 0
    s_add_u32 s47, s47, 33554432
    v_rcp_f32 v192, v148
    s_nop 0
    v_mul_f32 v192, v192, v198
    v_mul_f32 v100, v100, v192
    v_mul_f32_e64 v101, v101, v192
    v_cvt_pk_bf16_f32 v52, v100, v101
    v_mul_f32 v102, v102, v192
    v_mul_f32 v103, v103, v192
    v_cvt_pk_bf16_f32 v53, v102, v103
    v_mul_f32 v104, v104, v192
    v_mul_f32 v105, v105, v192
    v_cvt_pk_bf16_f32 v54, v104, v105
    v_mul_f32 v106, v106, v192
    v_mul_f32 v107, v107, v192
    v_cvt_pk_bf16_f32 v55, v106, v107
    v_mul_f32 v108, v108, v192
    v_mul_f32 v109, v109, v192
    v_cvt_pk_bf16_f32 v56, v108, v109
    v_mul_f32 v110, v110, v192
    v_mul_f32 v111, v111, v192
    v_cvt_pk_bf16_f32 v57, v110, v111
    v_mul_f32 v112, v112, v192
    v_mul_f32 v113, v113, v192
    v_cvt_pk_bf16_f32 v58, v112, v113
    v_mul_f32 v114, v114, v192
    v_mul_f32 v115, v115, v192
    v_cvt_pk_bf16_f32 v59, v114, v115
    buffer_store_dwordx4 v[52:55], v2, s[20:23], s47 offen sc1
    buffer_store_dwordx4 v[56:59], v2, s[20:23], s47 offen offset:1024 sc1
    s_add_u32 s37, s35, 65536
    buffer_load_dwordx4 v[64:67], v2, s[20:23], s37 offen offset:0
    buffer_load_dwordx4 v[68:71], v2, s[20:23], s37 offen offset:1024
    buffer_load_dwordx4 v[72:75], v2, s[20:23], s37 offen offset:2048
    buffer_load_dwordx4 v[76:79], v2, s[20:23], s37 offen offset:3072
    s_lshl_b32 s48, s28, 2
    s_add_u32 s48, s48, s59
    s_add_u32 s48, s48, 32
    s_waitcnt vmcnt(4)
    v_mov_b32 v192, 0
    v_mov_b32 v193, s58
    v_cmp_eq_u32 vcc, 0, v1
    s_and_saveexec_b64 s[50:51], vcc
    buffer_store_dword v193, v192, s[20:23], s48 offen sc1
    s_mov_b64 exec, s[50:51]
    s_nop 0
    s_add_u32 s37, s35, 73728
    buffer_load_dwordx4 v[80:83], v2, s[20:23], s37 offen offset:0
    buffer_load_dwordx4 v[84:87], v2, s[20:23], s37 offen offset:1024
    buffer_load_dwordx4 v[88:91], v2, s[20:23], s37 offen offset:2048
    buffer_load_dwordx4 v[92:95], v2, s[20:23], s37 offen offset:3072
    s_add_u32 s37, s35, 81920
    buffer_load_dwordx4 v[96:99], v2, s[20:23], s37 offen offset:0
    buffer_load_dwordx4 v[100:103], v2, s[20:23], s37 offen offset:1024
    buffer_load_dwordx4 v[104:107], v2, s[20:23], s37 offen offset:2048
    buffer_load_dwordx4 v[108:111], v2, s[20:23], s37 offen offset:3072
    s_add_u32 s37, s35, 90112
    buffer_load_dwordx4 v[112:115], v2, s[20:23], s37 offen offset:0
    buffer_load_dwordx4 v[116:119], v2, s[20:23], s37 offen offset:1024
    buffer_load_dwordx4 v[120:123], v2, s[20:23], s37 offen offset:2048
    buffer_load_dwordx4 v[124:127], v2, s[20:23], s37 offen offset:3072
    s_barrier
    s_and_b32 s48, s2, 1
    s_lshl_b32 s48, s48, 3
    s_lshr_b32 s49, s2, 5
    s_add_u32 s48, s48, s49
    s_lshl_b32 s48, s48, 7
    v_lshrrev_b32 v3, 3, v1
    s_and_b32 s49, s28, 3
    s_lshl_b32 s49, s49, 4
    v_add_u32 v3, s49, v3
    v_lshlrev_b32 v3, 11, v3
    v_and_b32 v4, 7, v1
    v_bfe_u32 v5, v1, 4, 1
    v_lshlrev_b32 v5, 2, v5
    v_xor_b32 v4, v4, v5
    v_lshl_add_u32 v3, v4, 4, v3
    v_add_u32_e64 v220, s48, v3
    v_add_u32 v221, 15360, v220
    s_lshl_b32 s48, s32, 17
    s_add_u32 s24, s84, s48
    s_addc_u32 s25, s85, 0
    s_nop 0
    s_sub_u32 s26, 0x200000, s48
    s_mov_b32 s27, 0x20000
    s_lshl_b32 s38, s28, 11
    s_nop 0
    s_mov_b32 s39, 1835008
    s_mov_b32 s12, s80
    s_mov_b32 s13, s81
    s_mov_b32 s14, 0x400000
    s_mov_b32 s15, 0x20000
    v_lshrrev_b32 v3, 5, v1
    v_lshlrev_b32 v3, 2, v3
    v_bfe_u32 v4, v1, 2, 2
    v_add_u32 v3, v3, v4
    v_lshlrev_b32 v3, 7, v3
    v_bfe_u32 v4, v1, 4, 1
    v_lshlrev_b32_e64 v4, 1, v4
    v_bfe_u32 v5, v1, 1, 1
    v_or_b32_e64 v4, v4, v5
    v_bfe_u32 v5, v1, 3, 1
    v_lshlrev_b32 v5, 2, v5
    v_xor_b32 v4, v4, v5
    v_lshl_add_u32 v3, v4, 4, v3
    v_and_b32_e64 v4, 1, v1
    v_lshl_add_u32 v3, v4, 3, v3
    s_lshl_b32 s48, s32, 13
    v_add_u32 v8, s48, v3
    v_xor_b32_e64 v9, 64, v8
    v_add_u32 v10, 65536, v8
    v_add_u32 v11, 65536, v9
    v_mov_b64 v[16:17], 0
    v_mov_b64 v[18:19], 0
    v_mov_b64 v[20:21], 0
    v_mov_b64 v[22:23], 0
    v_mov_b64 v[24:25], 0
    v_mov_b64 v[26:27], 0
    v_mov_b64 v[28:29], 0
    v_mov_b64 v[30:31], 0
    v_mov_b64 v[32:33], 0
    v_mov_b64 v[34:35], 0
    v_mov_b64 v[36:37], 0
    v_mov_b64 v[38:39], 0
    v_mov_b64 v[40:41], 0
    v_mov_b64 v[42:43], 0
    v_mov_b64 v[44:45], 0
    v_mov_b64 v[46:47], 0
    s_add_u32 m0, s38, 114688
    s_nop 0
    s_nop 0
    buffer_load_dwordx4 v220, s[24:27], s39 offen lds
    buffer_load_dwordx4 v221, s[24:27], s39 offen offset:1024 lds
    s_add_u32 s39, s39, 262144
    ds_read_b64_tr_b16 v[128:129], v8 offset:0
    ds_read_b64_tr_b16 v[130:131], v8 offset:1024
    ds_read_b64_tr_b16 v[132:133], v9 offset:0
    ds_read_b64_tr_b16 v[134:135], v9 offset:1024
    ds_read_b64_tr_b16 v[136:137], v8 offset:2048
    ds_read_b64_tr_b16 v[138:139], v8 offset:3072
    ds_read_b64_tr_b16 v[140:141], v9 offset:2048
    ds_read_b64_tr_b16 v[142:143], v9 offset:3072
    ds_read_b64_tr_b16 v[144:145], v8 offset:4096
    ds_read_b64_tr_b16 v[146:147], v8 offset:5120
    ds_read_b64_tr_b16 v[148:149], v9 offset:4096
    ds_read_b64_tr_b16 v[150:151], v9 offset:5120
    ds_read_b64_tr_b16 v[152:153], v8 offset:6144
    ds_read_b64_tr_b16 v[154:155], v8 offset:7168
    ds_read_b64_tr_b16 v[156:157], v9 offset:6144
    ds_read_b64_tr_b16 v[158:159], v9 offset:7168
    v_bfe_u32 v12, v1, 1, 3
    v_lshlrev_b32 v12, 12, v12
    v_and_b32 v13, 1, v1
    v_lshl_add_u32 v12, v13, 3, v12
    s_and_b32 s48, s31, 1
    s_lshl_b32 s48, s48, 4
    s_lshr_b32 s49, s31, 1
    s_lshl_b32 s49, s49, 2
    s_add_u32 s48, s48, s49
    s_lshl_b32 s49, s29, 7
    s_add_u32 s48, s48, s49
    s_lshl_b32 s49, s32, 11
    s_add_u32 s48, s48, s49
    s_nop 0
    s_add_u32 s52, s48, 29360160
    s_lshl_b32 s48, s28, 12
    v_add_u32 v6, s48, v2
    s_xor_b32 s48, s48, 16384
    v_add_u32 v7, s48, v2
    v_and_b32 v14, 31, v1
    s_lshl_b32 s48, s29, 7
    s_lshl_b32 s49, s31, 5
    s_add_u32 s48, s48, s49
    v_add_u32 v14, s48, v14
    v_lshlrev_b32 v14, 11, v14
    v_lshrrev_b32 v15, 5, v1
    v_lshl_add_u32 v14, v15, 4, v14
    s_lshl_b32 s48, s30, 7
    s_lshl_b32 s49, s32, 6
    s_add_u32 s57, s48, s49
    s_waitcnt vmcnt(15) lgkmcnt(0)
    s_barrier
    s_nop 0
    v_mfma_f32_32x32x16_bf16 v[16:31], v[128:131], v[64:67], v[16:31]
    ds_read_b64_tr_b16 v[160:161], v8 offset:16384
    ds_read_b64_tr_b16 v[162:163], v8 offset:17408
    s_lshl_b32 s48, s32, 17
    s_add_u32 s24, s82, s48
    s_addc_u32 s25, s83, 0
    s_mov_b32 s39, 0
    s_add_u32 m0, s38, 0
    s_nop 0
    v_mfma_f32_32x32x16_bf16 v[32:47], v[132:135], v[64:67], v[32:47]
    ds_read_b64_tr_b16 v[164:165], v9 offset:16384
    ds_read_b64_tr_b16 v[166:167], v9 offset:17408
    buffer_load_dwordx4 v220, s[24:27], s39 offen lds
    buffer_load_dwordx4 v221, s[24:27], s39 offen offset:1024 lds
    s_add_u32 s39, s39, 262144
    s_add_u32 s37, s35, 98304
    buffer_load_dwordx4 v[64:67], v2, s[20:23], s37 offen offset:0
    v_mfma_f32_32x32x16_bf16 v[16:31], v[136:139], v[68:71], v[16:31]
    ds_read_b64_tr_b16 v[168:169], v8 offset:18432
    ds_read_b64_tr_b16 v[170:171], v8 offset:19456
    v_mfma_f32_32x32x16_bf16 v[32:47], v[140:143], v[68:71], v[32:47]
    ds_read_b64_tr_b16 v[172:173], v9 offset:18432
    ds_read_b64_tr_b16 v[174:175], v9 offset:19456
    buffer_load_dwordx4 v[68:71], v2, s[20:23], s37 offen offset:1024
    v_mfma_f32_32x32x16_bf16 v[16:31], v[144:147], v[72:75], v[16:31]
    ds_read_b64_tr_b16 v[176:177], v8 offset:20480
    ds_read_b64_tr_b16 v[178:179], v8 offset:21504
    v_mfma_f32_32x32x16_bf16 v[32:47], v[148:151], v[72:75], v[32:47]
    ds_read_b64_tr_b16 v[180:181], v9 offset:20480
    ds_read_b64_tr_b16 v[182:183], v9 offset:21504
    buffer_load_dwordx4 v[72:75], v2, s[20:23], s37 offen offset:2048
    v_mfma_f32_32x32x16_bf16 v[16:31], v[152:155], v[76:79], v[16:31]
    ds_read_b64_tr_b16 v[184:185], v8 offset:22528
    ds_read_b64_tr_b16 v[186:187], v8 offset:23552
    v_mfma_f32_32x32x16_bf16 v[32:47], v[156:159], v[76:79], v[32:47]
    ds_read_b64_tr_b16 v[188:189], v9 offset:22528
    ds_read_b64_tr_b16 v[190:191], v9 offset:23552
    buffer_load_dwordx4 v[76:79], v2, s[20:23], s37 offen offset:3072
    s_waitcnt vmcnt(16) lgkmcnt(0)
    s_barrier
    buffer_load_dword v13, v12, s[20:23], s52 offen sc1
    v_mfma_f32_32x32x16_bf16 v[16:31], v[160:163], v[80:83], v[16:31]
    ds_read_b64_tr_b16 v[128:129], v8 offset:32768
    ds_read_b64_tr_b16 v[130:131], v8 offset:33792
    s_add_u32 m0, s38, 16384
    v_mfma_f32_32x32x16_bf16 v[32:47], v[164:167], v[80:83], v[32:47]
    ds_read_b64_tr_b16 v[132:133], v9 offset:32768
    ds_read_b64_tr_b16 v[134:135], v9 offset:33792
    buffer_load_dwordx4 v220, s[24:27], s39 offen lds
    buffer_load_dwordx4 v221, s[24:27], s39 offen offset:1024 lds
    s_add_u32 s39, s39, 262144
    s_add_u32 s37, s35, 106496
    buffer_load_dwordx4 v[80:83], v2, s[20:23], s37 offen offset:0
    v_mfma_f32_32x32x16_bf16 v[16:31], v[168:171], v[84:87], v[16:31]
    ds_read_b64_tr_b16 v[136:137], v8 offset:34816
    ds_read_b64_tr_b16 v[138:139], v8 offset:35840
    v_mfma_f32_32x32x16_bf16 v[32:47], v[172:175], v[84:87], v[32:47]
    ds_read_b64_tr_b16 v[140:141], v9 offset:34816
    ds_read_b64_tr_b16 v[142:143], v9 offset:35840
    buffer_load_dwordx4 v[84:87], v2, s[20:23], s37 offen offset:1024
    v_mfma_f32_32x32x16_bf16 v[16:31], v[176:179], v[88:91], v[16:31]
    ds_read_b64_tr_b16 v[144:145], v8 offset:36864
    ds_read_b64_tr_b16 v[146:147], v8 offset:37888
    v_mfma_f32_32x32x16_bf16 v[32:47], v[180:183], v[88:91], v[32:47]
    ds_read_b64_tr_b16 v[148:149], v9 offset:36864
    ds_read_b64_tr_b16 v[150:151], v9 offset:37888
    buffer_load_dwordx4 v[88:91], v2, s[20:23], s37 offen offset:2048
    v_mfma_f32_32x32x16_bf16 v[16:31], v[184:187], v[92:95], v[16:31]
    ds_read_b64_tr_b16 v[152:153], v8 offset:38912
    ds_read_b64_tr_b16 v[154:155], v8 offset:39936
    v_mfma_f32_32x32x16_bf16 v[32:47], v[188:191], v[92:95], v[32:47]
    ds_read_b64_tr_b16 v[156:157], v9 offset:38912
    ds_read_b64_tr_b16 v[158:159], v9 offset:39936
    buffer_load_dwordx4 v[92:95], v2, s[20:23], s37 offen offset:3072
    s_waitcnt vmcnt(19) lgkmcnt(0)
    s_barrier
    v_mfma_f32_32x32x16_bf16 v[16:31], v[128:131], v[96:99], v[16:31]
    ds_read_b64_tr_b16 v[160:161], v8 offset:49152
    ds_read_b64_tr_b16 v[162:163], v8 offset:50176
    s_add_u32 m0, s38, 32768
    v_mfma_f32_32x32x16_bf16 v[32:47], v[132:135], v[96:99], v[32:47]
    ds_read_b64_tr_b16 v[164:165], v9 offset:49152
    ds_read_b64_tr_b16 v[166:167], v9 offset:50176
    buffer_load_dwordx4 v220, s[24:27], s39 offen lds
    buffer_load_dwordx4 v221, s[24:27], s39 offen offset:1024 lds
    s_add_u32 s39, s39, 262144
    s_add_u32 s37, s35, 114688
    buffer_load_dwordx4 v[96:99], v2, s[20:23], s37 offen offset:0
    v_mfma_f32_32x32x16_bf16 v[16:31], v[136:139], v[100:103], v[16:31]
    ds_read_b64_tr_b16 v[168:169], v8 offset:51200
    ds_read_b64_tr_b16 v[170:171], v8 offset:52224
    v_mfma_f32_32x32x16_bf16 v[32:47], v[140:143], v[100:103], v[32:47]
    ds_read_b64_tr_b16 v[172:173], v9 offset:51200
    ds_read_b64_tr_b16 v[174:175], v9 offset:52224
    buffer_load_dwordx4 v[100:103], v2, s[20:23], s37 offen offset:1024
    v_mfma_f32_32x32x16_bf16 v[16:31], v[144:147], v[104:107], v[16:31]
    ds_read_b64_tr_b16 v[176:177], v8 offset:53248
    ds_read_b64_tr_b16 v[178:179], v8 offset:54272
    v_mfma_f32_32x32x16_bf16 v[32:47], v[148:151], v[104:107], v[32:47]
    ds_read_b64_tr_b16 v[180:181], v9 offset:53248
    ds_read_b64_tr_b16 v[182:183], v9 offset:54272
    buffer_load_dwordx4 v[104:107], v2, s[20:23], s37 offen offset:2048
    v_mfma_f32_32x32x16_bf16 v[16:31], v[152:155], v[108:111], v[16:31]
    ds_read_b64_tr_b16 v[184:185], v8 offset:55296
    ds_read_b64_tr_b16 v[186:187], v8 offset:56320
    v_mfma_f32_32x32x16_bf16 v[32:47], v[156:159], v[108:111], v[32:47]
    ds_read_b64_tr_b16 v[188:189], v9 offset:55296
    ds_read_b64_tr_b16 v[190:191], v9 offset:56320
    buffer_load_dwordx4 v[108:111], v2, s[20:23], s37 offen offset:3072
    s_waitcnt vmcnt(21) lgkmcnt(0)
    s_barrier
    v_mfma_f32_32x32x16_bf16 v[16:31], v[160:163], v[112:115], v[16:31]
    ds_read_b64_tr_b16 v[128:129], v10 offset:0
    ds_read_b64_tr_b16 v[130:131], v10 offset:1024
    s_add_u32 m0, s38, 49152
    v_mfma_f32_32x32x16_bf16 v[32:47], v[164:167], v[112:115], v[32:47]
    ds_read_b64_tr_b16 v[132:133], v11 offset:0
    ds_read_b64_tr_b16 v[134:135], v11 offset:1024
    buffer_load_dwordx4 v220, s[24:27], s39 offen lds
    buffer_load_dwordx4 v221, s[24:27], s39 offen offset:1024 lds
    s_add_u32 s39, s39, 262144
    s_add_u32 s37, s35, 122880
    buffer_load_dwordx4 v[112:115], v2, s[20:23], s37 offen offset:0
    v_mfma_f32_32x32x16_bf16 v[16:31], v[168:171], v[116:119], v[16:31]
    ds_read_b64_tr_b16 v[136:137], v10 offset:2048
    ds_read_b64_tr_b16 v[138:139], v10 offset:3072
    v_mfma_f32_32x32x16_bf16 v[32:47], v[172:175], v[116:119], v[32:47]
    ds_read_b64_tr_b16 v[140:141], v11 offset:2048
    ds_read_b64_tr_b16 v[142:143], v11 offset:3072
    buffer_load_dwordx4 v[116:119], v2, s[20:23], s37 offen offset:1024
    v_mfma_f32_32x32x16_bf16 v[16:31], v[176:179], v[120:123], v[16:31]
    ds_read_b64_tr_b16 v[144:145], v10 offset:4096
    ds_read_b64_tr_b16 v[146:147], v10 offset:5120
    v_mfma_f32_32x32x16_bf16 v[32:47], v[180:183], v[120:123], v[32:47]
    ds_read_b64_tr_b16 v[148:149], v11 offset:4096
    ds_read_b64_tr_b16 v[150:151], v11 offset:5120
    buffer_load_dwordx4 v[120:123], v2, s[20:23], s37 offen offset:2048
    v_mfma_f32_32x32x16_bf16 v[16:31], v[184:187], v[124:127], v[16:31]
    ds_read_b64_tr_b16 v[152:153], v10 offset:6144
    ds_read_b64_tr_b16 v[154:155], v10 offset:7168
    v_mfma_f32_32x32x16_bf16 v[32:47], v[188:191], v[124:127], v[32:47]
    ds_read_b64_tr_b16 v[156:157], v11 offset:6144
    ds_read_b64_tr_b16 v[158:159], v11 offset:7168
    buffer_load_dwordx4 v[124:127], v2, s[20:23], s37 offen offset:3072
    s_waitcnt vmcnt(18) lgkmcnt(0)
    s_barrier
    s_mov_b32 s53, 0
    s_branch L_sp_o2_7c
L_sp_o2_7:
    s_sleep 2
    s_nop 0
    buffer_load_dword v13, v12, s[20:23], s52 offen sc1
    s_waitcnt vmcnt(0)
L_sp_o2_7c:
    v_cmp_eq_u32 vcc, s58, v13
    s_add_u32 s53, s53, 1
    s_nop 0
    s_and_b32 s50, vcc_lo, 0xffff
    s_cmp_eq_u32 s50, 0xffff
    s_cbranch_scc1 L_ok_o2_8
    s_nop 0
    s_cmp_lt_u32 s53, 400000
    s_cbranch_scc1 L_sp_o2_7
L_ok_o2_8:
    s_nop 0
    v_mfma_f32_32x32x16_bf16 v[16:31], v[128:131], v[64:67], v[16:31]
    ds_read_b64_tr_b16 v[160:161], v10 offset:16384
    ds_read_b64_tr_b16 v[162:163], v10 offset:17408
    s_add_u32 m0, s38, 65536
    v_mfma_f32_32x32x16_bf16 v[32:47], v[132:135], v[64:67], v[32:47]
    ds_read_b64_tr_b16 v[164:165], v11 offset:16384
    ds_read_b64_tr_b16 v[166:167], v11 offset:17408
    buffer_load_dwordx4 v220, s[24:27], s39 offen lds
    buffer_load_dwordx4 v221, s[24:27], s39 offen offset:1024 lds
    s_add_u32 s39, s39, 262144
    s_add_u32 s37, s35, 0
    s_nop 0
    buffer_load_dwordx4 v[64:67], v2, s[20:23], s37 offen offset:0
    v_mfma_f32_32x32x16_bf16 v[16:31], v[136:139], v[68:71], v[16:31]
    ds_read_b64_tr_b16 v[168:169], v10 offset:18432
    ds_read_b64_tr_b16 v[170:171], v10 offset:19456
    v_mfma_f32_32x32x16_bf16 v[32:47], v[140:143], v[68:71], v[32:47]
    ds_read_b64_tr_b16 v[172:173], v11 offset:18432
    ds_read_b64_tr_b16 v[174:175], v11 offset:19456
    buffer_load_dwordx4 v[68:71], v2, s[20:23], s37 offen offset:1024
    v_mfma_f32_32x32x16_bf16 v[16:31], v[144:147], v[72:75], v[16:31]
    ds_read_b64_tr_b16 v[176:177], v10 offset:20480
    ds_read_b64_tr_b16 v[178:179], v10 offset:21504
    v_mfma_f32_32x32x16_bf16 v[32:47], v[148:151], v[72:75], v[32:47]
    ds_read_b64_tr_b16 v[180:181], v11 offset:20480
    ds_read_b64_tr_b16 v[182:183], v11 offset:21504
    buffer_load_dwordx4 v[72:75], v2, s[20:23], s37 offen offset:2048
    v_mfma_f32_32x32x16_bf16 v[16:31], v[152:155], v[76:79], v[16:31]
    ds_read_b64_tr_b16 v[184:185], v10 offset:22528
    ds_read_b64_tr_b16 v[186:187], v10 offset:23552
    v_mfma_f32_32x32x16_bf16 v[32:47], v[156:159], v[76:79], v[32:47]
    ds_read_b64_tr_b16 v[188:189], v11 offset:22528
    ds_read_b64_tr_b16 v[190:191], v11 offset:23552
    buffer_load_dwordx4 v[76:79], v2, s[20:23], s37 offen offset:3072
    s_waitcnt vmcnt(18) lgkmcnt(0)
    s_barrier
    v_mfma_f32_32x32x16_bf16 v[16:31], v[160:163], v[80:83], v[16:31]
    ds_read_b64_tr_b16 v[128:129], v10 offset:32768
    ds_read_b64_tr_b16 v[130:131], v10 offset:33792
    s_add_u32 m0, s38, 81920
    v_mfma_f32_32x32x16_bf16 v[32:47], v[164:167], v[80:83], v[32:47]
    ds_read_b64_tr_b16 v[132:133], v11 offset:32768
    ds_read_b64_tr_b16 v[134:135], v11 offset:33792
    buffer_load_dwordx4 v220, s[24:27], s39 offen lds
    buffer_load_dwordx4 v221, s[24:27], s39 offen offset:1024 lds
    s_add_u32 s39, s39, 262144
    s_add_u32 s37, s35, 8192
    buffer_load_dwordx4 v[80:83], v2, s[20:23], s37 offen offset:0
    v_mfma_f32_32x32x16_bf16 v[16:31], v[168:171], v[84:87], v[16:31]
    ds_read_b64_tr_b16 v[136:137], v10 offset:34816
    ds_read_b64_tr_b16 v[138:139], v10 offset:35840
    v_mfma_f32_32x32x16_bf16 v[32:47], v[172:175], v[84:87], v[32:47]
    ds_read_b64_tr_b16 v[140:141], v11 offset:34816
    ds_read_b64_tr_b16 v[142:143], v11 offset:35840
    buffer_load_dwordx4 v[84:87], v2, s[20:23], s37 offen offset:1024
    v_mfma_f32_32x32x16_bf16 v[16:31], v[176:179], v[88:91], v[16:31]
    ds_read_b64_tr_b16 v[144:145], v10 offset:36864
    ds_read_b64_tr_b16 v[146:147], v10 offset:37888
    v_mfma_f32_32x32x16_bf16 v[32:47], v[180:183], v[88:91], v[32:47]
    ds_read_b64_tr_b16 v[148:149], v11 offset:36864
    ds_read_b64_tr_b16 v[150:151], v11 offset:37888
    buffer_load_dwordx4 v[88:91], v2, s[20:23], s37 offen offset:2048
    v_mfma_f32_32x32x16_bf16 v[16:31], v[184:187], v[92:95], v[16:31]
    ds_read_b64_tr_b16 v[152:153], v10 offset:38912
    ds_read_b64_tr_b16 v[154:155], v10 offset:39936
    v_mfma_f32_32x32x16_bf16 v[32:47], v[188:191], v[92:95], v[32:47]
    ds_read_b64_tr_b16 v[156:157], v11 offset:38912
    ds_read_b64_tr_b16 v[158:159], v11 offset:39936
    buffer_load_dwordx4 v[92:95], v2, s[20:23], s37 offen offset:3072
    s_waitcnt vmcnt(18) lgkmcnt(0)
    s_barrier
    v_mfma_f32_32x32x16_bf16 v[16:31], v[128:131], v[96:99], v[16:31]
    ds_read_b64_tr_b16 v[160:161], v10 offset:49152
    ds_read_b64_tr_b16 v[162:163], v10 offset:50176
    s_add_u32 m0, s38, 98304
    v_mfma_f32_32x32x16_bf16 v[32:47], v[132:135], v[96:99], v[32:47]
    ds_read_b64_tr_b16 v[164:165], v11 offset:49152
    ds_read_b64_tr_b16 v[166:167], v11 offset:50176
    buffer_load_dwordx4 v220, s[24:27], s39 offen lds
    buffer_load_dwordx4 v221, s[24:27], s39 offen offset:1024 lds
    s_add_u32 s39, s39, 262144
    s_add_u32 s37, s35, 16384
    buffer_load_dwordx4 v[96:99], v2, s[20:23], s37 offen offset:0
    v_mfma_f32_32x32x16_bf16 v[16:31], v[136:139], v[100:103], v[16:31]
    ds_read_b64_tr_b16 v[168:169], v10 offset:51200
    ds_read_b64_tr_b16 v[170:171], v10 offset:52224
    v_mfma_f32_32x32x16_bf16 v[32:47], v[140:143], v[100:103], v[32:47]
    ds_read_b64_tr_b16 v[172:173], v11 offset:51200
    ds_read_b64_tr_b16 v[174:175], v11 offset:52224
    buffer_load_dwordx4 v[100:103], v2, s[20:23], s37 offen offset:1024
    v_mfma_f32_32x32x16_bf16 v[16:31], v[144:147], v[104:107], v[16:31]
    ds_read_b64_tr_b16 v[176:177], v10 offset:53248
    ds_read_b64_tr_b16 v[178:179], v10 offset:54272
    v_mfma_f32_32x32x16_bf16 v[32:47], v[148:151], v[104:107], v[32:47]
    ds_read_b64_tr_b16 v[180:181], v11 offset:53248
    ds_read_b64_tr_b16 v[182:183], v11 offset:54272
    buffer_load_dwordx4 v[104:107], v2, s[20:23], s37 offen offset:2048
    v_mfma_f32_32x32x16_bf16 v[16:31], v[152:155], v[108:111], v[16:31]
    ds_read_b64_tr_b16 v[184:185], v10 offset:55296
    ds_read_b64_tr_b16 v[186:187], v10 offset:56320
    v_mfma_f32_32x32x16_bf16 v[32:47], v[156:159], v[108:111], v[32:47]
    ds_read_b64_tr_b16 v[188:189], v11 offset:55296
    ds_read_b64_tr_b16 v[190:191], v11 offset:56320
    buffer_load_dwordx4 v[108:111], v2, s[20:23], s37 offen offset:3072
    s_waitcnt vmcnt(18) lgkmcnt(0)
    s_barrier
    v_mfma_f32_32x32x16_bf16 v[16:31], v[160:163], v[112:115], v[16:31]
    ds_read_b64_tr_b16 v[128:129], v8 offset:0
    ds_read_b64_tr_b16 v[130:131], v8 offset:1024
    s_add_u32 m0, s38, 114688
    v_mfma_f32_32x32x16_bf16 v[32:47], v[164:167], v[112:115], v[32:47]
    ds_read_b64_tr_b16 v[132:133], v9 offset:0
    ds_read_b64_tr_b16 v[134:135], v9 offset:1024
    buffer_load_dwordx4 v220, s[24:27], s39 offen lds
    buffer_load_dwordx4 v221, s[24:27], s39 offen offset:1024 lds
    s_add_u32 s39, s39, 262144
    s_add_u32 s37, s35, 24576
    buffer_load_dwordx4 v[112:115], v2, s[20:23], s37 offen offset:0
    v_mfma_f32_32x32x16_bf16 v[16:31], v[168:171], v[116:119], v[16:31]
    ds_read_b64_tr_b16 v[136:137], v8 offset:2048
    ds_read_b64_tr_b16 v[138:139], v8 offset:3072
    v_mfma_f32_32x32x16_bf16 v[32:47], v[172:175], v[116:119], v[32:47]
    ds_read_b64_tr_b16 v[140:141], v9 offset:2048
    ds_read_b64_tr_b16 v[142:143], v9 offset:3072
    buffer_load_dwordx4 v[116:119], v2, s[20:23], s37 offen offset:1024
    v_mfma_f32_32x32x16_bf16 v[16:31], v[176:179], v[120:123], v[16:31]
    ds_read_b64_tr_b16 v[144:145], v8 offset:4096
    ds_read_b64_tr_b16 v[146:147], v8 offset:5120
    v_mfma_f32_32x32x16_bf16 v[32:47], v[180:183], v[120:123], v[32:47]
    ds_read_b64_tr_b16 v[148:149], v9 offset:4096
    ds_read_b64_tr_b16 v[150:151], v9 offset:5120
    buffer_load_dwordx4 v[120:123], v2, s[20:23], s37 offen offset:2048
    v_mfma_f32_32x32x16_bf16 v[16:31], v[184:187], v[124:127], v[16:31]
    ds_read_b64_tr_b16 v[152:153], v8 offset:6144
    ds_read_b64_tr_b16 v[154:155], v8 offset:7168
    v_mfma_f32_32x32x16_bf16 v[32:47], v[188:191], v[124:127], v[32:47]
    ds_read_b64_tr_b16 v[156:157], v9 offset:6144
    ds_read_b64_tr_b16 v[158:159], v9 offset:7168
    buffer_load_dwordx4 v[124:127], v2, s[20:23], s37 offen offset:3072
    s_waitcnt vmcnt(18) lgkmcnt(0)
    s_barrier
    v_mfma_f32_32x32x16_bf16 v[16:31], v[128:131], v[64:67], v[16:31]
    ds_read_b64_tr_b16 v[160:161], v8 offset:16384
    ds_read_b64_tr_b16 v[162:163], v8 offset:17408
    v_mfma_f32_32x32x16_bf16 v[32:47], v[132:135], v[64:67], v[32:47]
    ds_read_b64_tr_b16 v[164:165], v9 offset:16384
    ds_read_b64_tr_b16 v[166:167], v9 offset:17408
    s_add_u32 s37, s35, 32768
    buffer_load_dwordx4 v[64:67], v2, s[20:23], s37 offen offset:0
    v_mfma_f32_32x32x16_bf16 v[16:31], v[136:139], v[68:71], v[16:31]
    ds_read_b64_tr_b16 v[168:169], v8 offset:18432
    ds_read_b64_tr_b16 v[170:171], v8 offset:19456
    v_mfma_f32_32x32x16_bf16 v[32:47], v[140:143], v[68:71], v[32:47]
    ds_read_b64_tr_b16 v[172:173], v9 offset:18432
    ds_read_b64_tr_b16 v[174:175], v9 offset:19456
    buffer_load_dwordx4 v[68:71], v2, s[20:23], s37 offen offset:1024
    v_mfma_f32_32x32x16_bf16 v[16:31], v[144:147], v[72:75], v[16:31]
    ds_read_b64_tr_b16 v[176:177], v8 offset:20480
    ds_read_b64_tr_b16 v[178:179], v8 offset:21504
    v_mfma_f32_32x32x16_bf16 v[32:47], v[148:151], v[72:75], v[32:47]
    ds_read_b64_tr_b16 v[180:181], v9 offset:20480
    ds_read_b64_tr_b16 v[182:183], v9 offset:21504
    buffer_load_dwordx4 v[72:75], v2, s[20:23], s37 offen offset:2048
    v_mfma_f32_32x32x16_bf16 v[16:31], v[152:155], v[76:79], v[16:31]
    ds_read_b64_tr_b16 v[184:185], v8 offset:22528
    ds_read_b64_tr_b16 v[186:187], v8 offset:23552
    v_mfma_f32_32x32x16_bf16 v[32:47], v[156:159], v[76:79], v[32:47]
    ds_read_b64_tr_b16 v[188:189], v9 offset:22528
    ds_read_b64_tr_b16 v[190:191], v9 offset:23552
    buffer_load_dwordx4 v[76:79], v2, s[20:23], s37 offen offset:3072
    s_waitcnt vmcnt(16) lgkmcnt(0)
    s_barrier
    v_mfma_f32_32x32x16_bf16 v[16:31], v[160:163], v[80:83], v[16:31]
    ds_read_b64_tr_b16 v[128:129], v8 offset:32768
    ds_read_b64_tr_b16 v[130:131], v8 offset:33792
    v_mfma_f32_32x32x16_bf16 v[32:47], v[164:167], v[80:83], v[32:47]
    ds_read_b64_tr_b16 v[132:133], v9 offset:32768
    ds_read_b64_tr_b16 v[134:135], v9 offset:33792
    s_add_u32 s37, s35, 40960
    buffer_load_dwordx4 v[80:83], v2, s[20:23], s37 offen offset:0
    v_mfma_f32_32x32x16_bf16 v[16:31], v[168:171], v[84:87], v[16:31]
    ds_read_b64_tr_b16 v[136:137], v8 offset:34816
    ds_read_b64_tr_b16 v[138:139], v8 offset:35840
    v_mfma_f32_32x32x16_bf16 v[32:47], v[172:175], v[84:87], v[32:47]
    ds_read_b64_tr_b16 v[140:141], v9 offset:34816
    ds_read_b64_tr_b16 v[142:143], v9 offset:35840
    buffer_load_dwordx4 v[84:87], v2, s[20:23], s37 offen offset:1024
    v_mfma_f32_32x32x16_bf16 v[16:31], v[176:179], v[88:91], v[16:31]
    ds_read_b64_tr_b16 v[144:145], v8 offset:36864
    ds_read_b64_tr_b16 v[146:147], v8 offset:37888
    v_mfma_f32_32x32x16_bf16 v[32:47], v[180:183], v[88:91], v[32:47]
    ds_read_b64_tr_b16 v[148:149], v9 offset:36864
    ds_read_b64_tr_b16 v[150:151], v9 offset:37888
    buffer_load_dwordx4 v[88:91], v2, s[20:23], s37 offen offset:2048
    v_mfma_f32_32x32x16_bf16 v[16:31], v[184:187], v[92:95], v[16:31]
    ds_read_b64_tr_b16 v[152:153], v8 offset:38912
    ds_read_b64_tr_b16 v[154:155], v8 offset:39936
    v_mfma_f32_32x32x16_bf16 v[32:47], v[188:191], v[92:95], v[32:47]
    ds_read_b64_tr_b16 v[156:157], v9 offset:38912
    ds_read_b64_tr_b16 v[158:159], v9 offset:39936
    buffer_load_dwordx4 v[92:95], v2, s[20:23], s37 offen offset:3072
    s_waitcnt vmcnt(14) lgkmcnt(0)
    s_barrier
    v_mfma_f32_32x32x16_bf16 v[16:31], v[128:131], v[96:99], v[16:31]
    ds_read_b64_tr_b16 v[160:161], v8 offset:49152
    ds_read_b64_tr_b16 v[162:163], v8 offset:50176
    v_mfma_f32_32x32x16_bf16 v[32:47], v[132:135], v[96:99], v[32:47]
    ds_read_b64_tr_b16 v[164:165], v9 offset:49152
    ds_read_b64_tr_b16 v[166:167], v9 offset:50176
    s_add_u32 s37, s35, 49152
    buffer_load_dwordx4 v[96:99], v2, s[20:23], s37 offen offset:0
    v_mfma_f32_32x32x16_bf16 v[16:31], v[136:139], v[100:103], v[16:31]
    ds_read_b64_tr_b16 v[168:169], v8 offset:51200
    ds_read_b64_tr_b16 v[170:171], v8 offset:52224
    v_mfma_f32_32x32x16_bf16 v[32:47], v[140:143], v[100:103], v[32:47]
    ds_read_b64_tr_b16 v[172:173], v9 offset:51200
    ds_read_b64_tr_b16 v[174:175], v9 offset:52224
    buffer_load_dwordx4 v[100:103], v2, s[20:23], s37 offen offset:1024
    v_mfma_f32_32x32x16_bf16 v[16:31], v[144:147], v[104:107], v[16:31]
    ds_read_b64_tr_b16 v[176:177], v8 offset:53248
    ds_read_b64_tr_b16 v[178:179], v8 offset:54272
    v_mfma_f32_32x32x16_bf16 v[32:47], v[148:151], v[104:107], v[32:47]
    ds_read_b64_tr_b16 v[180:181], v9 offset:53248
    ds_read_b64_tr_b16 v[182:183], v9 offset:54272
    buffer_load_dwordx4 v[104:107], v2, s[20:23], s37 offen offset:2048
    v_mfma_f32_32x32x16_bf16 v[16:31], v[152:155], v[108:111], v[16:31]
    ds_read_b64_tr_b16 v[184:185], v8 offset:55296
    ds_read_b64_tr_b16 v[186:187], v8 offset:56320
    v_mfma_f32_32x32x16_bf16 v[32:47], v[156:159], v[108:111], v[32:47]
    ds_read_b64_tr_b16 v[188:189], v9 offset:55296
    ds_read_b64_tr_b16 v[190:191], v9 offset:56320
    buffer_load_dwordx4 v[108:111], v2, s[20:23], s37 offen offset:3072
    s_waitcnt vmcnt(12) lgkmcnt(0)
    s_barrier
    v_mfma_f32_32x32x16_bf16 v[16:31], v[160:163], v[112:115], v[16:31]
    ds_read_b64_tr_b16 v[128:129], v10 offset:0
    ds_read_b64_tr_b16 v[130:131], v10 offset:1024
    v_mfma_f32_32x32x16_bf16 v[32:47], v[164:167], v[112:115], v[32:47]
    ds_read_b64_tr_b16 v[132:133], v11 offset:0
    ds_read_b64_tr_b16 v[134:135], v11 offset:1024
    s_add_u32 s37, s35, 57344
    buffer_load_dwordx4 v[112:115], v2, s[20:23], s37 offen offset:0
    v_mfma_f32_32x32x16_bf16 v[16:31], v[168:171], v[116:119], v[16:31]
    ds_read_b64_tr_b16 v[136:137], v10 offset:2048
    ds_read_b64_tr_b16 v[138:139], v10 offset:3072
    v_mfma_f32_32x32x16_bf16 v[32:47], v[172:175], v[116:119], v[32:47]
    ds_read_b64_tr_b16 v[140:141], v11 offset:2048
    ds_read_b64_tr_b16 v[142:143], v11 offset:3072
    buffer_load_dwordx4 v[116:119], v2, s[20:23], s37 offen offset:1024
    v_mfma_f32_32x32x16_bf16 v[16:31], v[176:179], v[120:123], v[16:31]
    ds_read_b64_tr_b16 v[144:145], v10 offset:4096
    ds_read_b64_tr_b16 v[146:147], v10 offset:5120
    v_mfma_f32_32x32x16_bf16 v[32:47], v[180:183], v[120:123], v[32:47]
    ds_read_b64_tr_b16 v[148:149], v11 offset:4096
    ds_read_b64_tr_b16 v[150:151], v11 offset:5120
    buffer_load_dwordx4 v[120:123], v2, s[20:23], s37 offen offset:2048
    v_mfma_f32_32x32x16_bf16 v[16:31], v[184:187], v[124:127], v[16:31]
    ds_read_b64_tr_b16 v[152:153], v10 offset:6144
    ds_read_b64_tr_b16 v[154:155], v10 offset:7168
    v_mfma_f32_32x32x16_bf16 v[32:47], v[188:191], v[124:127], v[32:47]
    ds_read_b64_tr_b16 v[156:157], v11 offset:6144
    ds_read_b64_tr_b16 v[158:159], v11 offset:7168
    buffer_load_dwordx4 v[124:127], v2, s[20:23], s37 offen offset:3072
    s_waitcnt vmcnt(12) lgkmcnt(0)
    s_barrier
    v_mfma_f32_32x32x16_bf16 v[16:31], v[128:131], v[64:67], v[16:31]
    ds_read_b64_tr_b16 v[160:161], v10 offset:16384
    ds_read_b64_tr_b16 v[162:163], v10 offset:17408
    v_mfma_f32_32x32x16_bf16 v[32:47], v[132:135], v[64:67], v[32:47]
    ds_read_b64_tr_b16 v[164:165], v11 offset:16384
    ds_read_b64_tr_b16 v[166:167], v11 offset:17408
    v_mfma_f32_32x32x16_bf16 v[16:31], v[136:139], v[68:71], v[16:31]
    ds_read_b64_tr_b16 v[168:169], v10 offset:18432
    ds_read_b64_tr_b16 v[170:171], v10 offset:19456
    v_mfma_f32_32x32x16_bf16 v[32:47], v[140:143], v[68:71], v[32:47]
    ds_read_b64_tr_b16 v[172:173], v11 offset:18432
    ds_read_b64_tr_b16 v[174:175], v11 offset:19456
    v_mfma_f32_32x32x16_bf16 v[16:31], v[144:147], v[72:75], v[16:31]
    ds_read_b64_tr_b16 v[176:177], v10 offset:20480
    ds_read_b64_tr_b16 v[178:179], v10 offset:21504
    v_mfma_f32_32x32x16_bf16 v[32:47], v[148:151], v[72:75], v[32:47]
    ds_read_b64_tr_b16 v[180:181], v11 offset:20480
    ds_read_b64_tr_b16 v[182:183], v11 offset:21504
    v_mfma_f32_32x32x16_bf16 v[16:31], v[152:155], v[76:79], v[16:31]
    ds_read_b64_tr_b16 v[184:185], v10 offset:22528
    ds_read_b64_tr_b16 v[186:187], v10 offset:23552
    v_mfma_f32_32x32x16_bf16 v[32:47], v[156:159], v[76:79], v[32:47]
    ds_read_b64_tr_b16 v[188:189], v11 offset:22528
    ds_read_b64_tr_b16 v[190:191], v11 offset:23552
    s_waitcnt vmcnt(8) lgkmcnt(0)
    s_barrier
    v_mfma_f32_32x32x16_bf16 v[16:31], v[160:163], v[80:83], v[16:31]
    ds_read_b64_tr_b16 v[128:129], v10 offset:32768
    ds_read_b64_tr_b16 v[130:131], v10 offset:33792
    v_mfma_f32_32x32x16_bf16 v[32:47], v[164:167], v[80:83], v[32:47]
    ds_read_b64_tr_b16 v[132:133], v11 offset:32768
    ds_read_b64_tr_b16 v[134:135], v11 offset:33792
    v_mfma_f32_32x32x16_bf16 v[16:31], v[168:171], v[84:87], v[16:31]
    ds_read_b64_tr_b16 v[136:137], v10 offset:34816
    ds_read_b64_tr_b16 v[138:139], v10 offset:35840
    v_mfma_f32_32x32x16_bf16 v[32:47], v[172:175], v[84:87], v[32:47]
    ds_read_b64_tr_b16 v[140:141], v11 offset:34816
    ds_read_b64_tr_b16 v[142:143], v11 offset:35840
    v_mfma_f32_32x32x16_bf16 v[16:31], v[176:179], v[88:91], v[16:31]
    ds_read_b64_tr_b16 v[144:145], v10 offset:36864
    ds_read_b64_tr_b16 v[146:147], v10 offset:37888
    v_mfma_f32_32x32x16_bf16 v[32:47], v[180:183], v[88:91], v[32:47]
    ds_read_b64_tr_b16 v[148:149], v11 offset:36864
    ds_read_b64_tr_b16 v[150:151], v11 offset:37888
    v_mfma_f32_32x32x16_bf16 v[16:31], v[184:187], v[92:95], v[16:31]
    ds_read_b64_tr_b16 v[152:153], v10 offset:38912
    ds_read_b64_tr_b16 v[154:155], v10 offset:39936
    v_mfma_f32_32x32x16_bf16 v[32:47], v[188:191], v[92:95], v[32:47]
    ds_read_b64_tr_b16 v[156:157], v11 offset:38912
    ds_read_b64_tr_b16 v[158:159], v11 offset:39936
    s_waitcnt vmcnt(4) lgkmcnt(0)
    s_barrier
    v_mfma_f32_32x32x16_bf16 v[16:31], v[128:131], v[96:99], v[16:31]
    ds_read_b64_tr_b16 v[160:161], v10 offset:49152
    ds_read_b64_tr_b16 v[162:163], v10 offset:50176
    v_mfma_f32_32x32x16_bf16 v[32:47], v[132:135], v[96:99], v[32:47]
    ds_read_b64_tr_b16 v[164:165], v11 offset:49152
    ds_read_b64_tr_b16 v[166:167], v11 offset:50176
    v_mfma_f32_32x32x16_bf16 v[16:31], v[136:139], v[100:103], v[16:31]
    ds_read_b64_tr_b16 v[168:169], v10 offset:51200
    ds_read_b64_tr_b16 v[170:171], v10 offset:52224
    v_mfma_f32_32x32x16_bf16 v[32:47], v[140:143], v[100:103], v[32:47]
    ds_read_b64_tr_b16 v[172:173], v11 offset:51200
    ds_read_b64_tr_b16 v[174:175], v11 offset:52224
    v_mfma_f32_32x32x16_bf16 v[16:31], v[144:147], v[104:107], v[16:31]
    ds_read_b64_tr_b16 v[176:177], v10 offset:53248
    ds_read_b64_tr_b16 v[178:179], v10 offset:54272
    v_mfma_f32_32x32x16_bf16 v[32:47], v[148:151], v[104:107], v[32:47]
    ds_read_b64_tr_b16 v[180:181], v11 offset:53248
    ds_read_b64_tr_b16 v[182:183], v11 offset:54272
    v_mfma_f32_32x32x16_bf16 v[16:31], v[152:155], v[108:111], v[16:31]
    ds_read_b64_tr_b16 v[184:185], v10 offset:55296
    ds_read_b64_tr_b16 v[186:187], v10 offset:56320
    v_mfma_f32_32x32x16_bf16 v[32:47], v[156:159], v[108:111], v[32:47]
    ds_read_b64_tr_b16 v[188:189], v11 offset:55296
    ds_read_b64_tr_b16 v[190:191], v11 offset:56320
    s_waitcnt vmcnt(0) lgkmcnt(0)
    s_barrier
    v_mfma_f32_32x32x16_bf16 v[16:31], v[160:163], v[112:115], v[16:31]
    v_mfma_f32_32x32x16_bf16 v[32:47], v[164:167], v[112:115], v[32:47]
    v_mfma_f32_32x32x16_bf16 v[16:31], v[168:171], v[116:119], v[16:31]
    v_mfma_f32_32x32x16_bf16 v[32:47], v[172:175], v[116:119], v[32:47]
    v_mfma_f32_32x32x16_bf16 v[16:31], v[176:179], v[120:123], v[16:31]
    v_mfma_f32_32x32x16_bf16 v[32:47], v[180:183], v[120:123], v[32:47]
    v_mfma_f32_32x32x16_bf16 v[16:31], v[184:187], v[124:127], v[16:31]
    v_mfma_f32_32x32x16_bf16 v[32:47], v[188:191], v[124:127], v[32:47]
    s_cmp_eq_u32 s32, 1
    s_cbranch_scc1 L_o_br1
    s_nop 9
    s_nop 0
    ds_write_b128 v6, v[32:35] offset:0
    ds_write_b128 v6, v[36:39] offset:1024
    ds_write_b128 v6, v[40:43] offset:2048
    ds_write_b128 v6, v[44:47] offset:3072
    s_waitcnt lgkmcnt(0)
    s_barrier
    ds_read_b128 v[64:67], v7 offset:0
    ds_read_b128 v[68:71], v7 offset:1024
    ds_read_b128 v[72:75], v7 offset:2048
    ds_read_b128 v[76:79], v7 offset:3072
    s_waitcnt lgkmcnt(3)
    s_nop 0
    v_pk_add_f32 v[16:17], v[16:17], v[64:65]
    v_pk_add_f32 v[18:19], v[18:19], v[66:67]
    v_cvt_pk_bf16_f32 v80, v16, v17
    v_cvt_pk_bf16_f32 v81, v18, v19
    s_waitcnt lgkmcnt(2)
    s_nop 0
    v_pk_add_f32 v[20:21], v[20:21], v[68:69]
    v_pk_add_f32 v[22:23], v[22:23], v[70:71]
    v_cvt_pk_bf16_f32 v82, v20, v21
    v_cvt_pk_bf16_f32 v83, v22, v23
    s_waitcnt lgkmcnt(1)
    s_nop 0
    v_pk_add_f32 v[24:25], v[24:25], v[72:73]
    v_pk_add_f32 v[26:27], v[26:27], v[74:75]
    v_cvt_pk_bf16_f32 v84, v24, v25
    v_cvt_pk_bf16_f32 v85, v26, v27
    s_waitcnt lgkmcnt(0)
    s_nop 0
    v_pk_add_f32 v[28:29], v[28:29], v[76:77]
    v_pk_add_f32 v[30:31], v[30:31], v[78:79]
    v_cvt_pk_bf16_f32 v86, v28, v29
    v_cvt_pk_bf16_f32 v87, v30, v31
    v_permlane32_swap_b32 v80, v82
    v_permlane32_swap_b32 v81, v83
    v_permlane32_swap_b32 v84, v86
    v_permlane32_swap_b32 v85, v87
    buffer_store_dwordx4 v[80:83], v14, s[12:15], s57 offen
    buffer_store_dwordx4 v[84:87], v14, s[12:15], s57 offen offset:32
    s_branch L_o_end
L_o_br1:
    s_nop 8
    ds_write_b128 v6, v[16:19] offset:0
    ds_write_b128 v6, v[20:23] offset:1024
    ds_write_b128 v6, v[24:27] offset:2048
    ds_write_b128 v6, v[28:31] offset:3072
    s_waitcnt lgkmcnt(0)
    s_barrier
    ds_read_b128 v[64:67], v7 offset:0
    ds_read_b128 v[68:71], v7 offset:1024
    ds_read_b128 v[72:75], v7 offset:2048
    ds_read_b128 v[76:79], v7 offset:3072
    s_waitcnt lgkmcnt(3)
    s_nop 0
    v_pk_add_f32 v[32:33], v[32:33], v[64:65]
    v_pk_add_f32 v[34:35], v[34:35], v[66:67]
    v_cvt_pk_bf16_f32 v80, v32, v33
    v_cvt_pk_bf16_f32 v81, v34, v35
    s_waitcnt lgkmcnt(2)
    s_nop 0
    v_pk_add_f32 v[36:37], v[36:37], v[68:69]
    v_pk_add_f32 v[38:39], v[38:39], v[70:71]
    v_cvt_pk_bf16_f32 v82, v36, v37
    v_cvt_pk_bf16_f32 v83, v38, v39
    s_waitcnt lgkmcnt(1)
    s_nop 0
    v_pk_add_f32 v[40:41], v[40:41], v[72:73]
    v_pk_add_f32 v[42:43], v[42:43], v[74:75]
    v_cvt_pk_bf16_f32 v84, v40, v41
    v_cvt_pk_bf16_f32 v85, v42, v43
    s_waitcnt lgkmcnt(0)
    s_nop 0
    v_pk_add_f32 v[44:45], v[44:45], v[76:77]
    v_pk_add_f32 v[46:47], v[46:47], v[78:79]
    v_cvt_pk_bf16_f32 v86, v44, v45
    v_cvt_pk_bf16_f32 v87, v46, v47
    v_permlane32_swap_b32 v80, v82
    v_permlane32_swap_b32 v81, v83
    v_permlane32_swap_b32 v84, v86
    v_permlane32_swap_b32 v85, v87
    buffer_store_dwordx4 v[80:83], v14, s[12:15], s57 offen
    buffer_store_dwordx4 v[84:87], v14, s[12:15], s57 offen offset:32
L_o_end:
L_end:
    s_endpgm
L_codeend:
.section .rodata,"a"
.p2align 6
.amdhsa_kernel gated_mix__softmax_full_mha__linear_kernel_hedgehog__prompt_kernel
  .amdhsa_next_free_vgpr 256
  .amdhsa_next_free_sgpr 102
  .amdhsa_accum_offset 256
  .amdhsa_group_segment_fixed_size 0
  .amdhsa_kernarg_size 88
  .amdhsa_user_sgpr_count 2
  .amdhsa_user_sgpr_kernarg_segment_ptr 1
  .amdhsa_system_sgpr_workgroup_id_x 1
.end_amdhsa_kernel
.text
```
